```python
import torch

def _softmax(x, axis=-1):
    return torch.softmax(x, dim=axis)
def _gelu(x):
    return torch.nn.functional.gelu(x, approximate="tanh")
def _silu(x):
    return torch.nn.functional.silu(x)
def _sigmoid(x):
    return torch.sigmoid(x)
def _layernorm(x, axis=-1, eps=1e-5):
    m = x.mean(dim=axis, keepdim=True)
    v = x.var(dim=axis, keepdim=True, unbiased=False)
    return (x - m) / torch.sqrt(v + eps)
def _scatter_add(tgt, idx, src, axis=0):
    return tgt.clone().index_add_(axis, idx, src)
def _segment_sum(src, seg, n):
    out = torch.zeros((n,) + src.shape[1:], dtype=src.dtype)
    return out.index_add_(0, seg, src)
def _pad(x, pw):
    flat = tuple(v for pair in reversed(pw) for v in pair)
    return torch.nn.functional.pad(x, flat)

kernel_name = 'recurrent_scan__mha_block_cached__dense_activation_squared_relu__decode'

def setup_inputs():

    _w = (lambda a: (lambda t: t.to(torch.bfloat16) if t.is_floating_point() else t)(torch.as_tensor(a)))
    def _A_setup():
        B, Sq, D = 2, 1, 576
        H, Sk, Dh = 32, 4096, 128
        return {
            "x": _w((lambda *s: torch.randn(*s, dtype=torch.bfloat16) * 0.05)(B, Sq, D)),
            "k_cache": _w((lambda *s: torch.randn(*s, dtype=torch.bfloat16) * 0.8)(B, H, Sk, Dh)),
            "v_cache": _w((lambda *s: torch.randn(*s, dtype=torch.bfloat16) * 0.2)(B, H, Sk, Dh)),
            "wq": _w((lambda *s: torch.randn(*s, dtype=torch.bfloat16) * 0.8)(D, H * Dh) * (D ** -0.5)),
            "wo": _w((lambda *s: torch.randn(*s, dtype=torch.bfloat16) * 0.2)(H * Dh, D) * ((H * Dh) ** -0.5)),
        }
    _A_in = _A_setup()

    def _B_setup():
        B, S, D, F = 2, 1, 576, 4608
        return {
            "x": _w((lambda *s: torch.randn(*s, dtype=torch.bfloat16) * 0.05)(B, S, D)),
            "w1": _w((lambda *s: torch.randn(*s, dtype=torch.bfloat16) * 0.1)(D, F)),
            "b1": _w((lambda *s: torch.randn(*s, dtype=torch.bfloat16) * 0.8)(F)),
            "w2": _w((lambda *s: torch.randn(*s, dtype=torch.bfloat16) * 0.1)(F, D)),
            "b2": _w((lambda *s: torch.randn(*s, dtype=torch.bfloat16) * 12.8)(D)),
        }
    _B_in = _B_setup()

    return {
        "A_x": _A_in["x"],
        "A_k_cache": _A_in["k_cache"],
        "A_v_cache": _A_in["v_cache"],
        "A_wq": _A_in["wq"],
        "A_wo": _A_in["wo"],
        "B_x": _B_in["x"],
        "B_w1": _B_in["w1"],
        "B_b1": _B_in["b1"],
        "B_w2": _B_in["w2"],
        "B_b2": _B_in["b2"],
    }

def reference(A_x, A_k_cache, A_v_cache, A_wq, A_wo, B_x, B_w1, B_b1, B_w2, B_b2):
    def _A_ref(x, k_cache, v_cache, wq, wo):
        B, Sq, D = x.shape
        H, Dh = 32, 128
        q = (lambda x, *d: x.permute(*d))((x @ wq).reshape(B, Sq, H, Dh), 0, 2, 1, 3)
        scores = torch.einsum("bhqd,bhkd->bhqk", q, k_cache) * (Dh ** -0.5)
        p = _softmax(scores, axis=-1)
        o = torch.einsum("bhqk,bhkd->bhqd", p, v_cache)
        return (lambda x, *d: x.permute(*d))(o, 0, 2, 1, 3).reshape(B, Sq, H * Dh) @ wo

    def _B_ref(x, w1, b1, w2, b2):
        h = torch.einsum("bsd,df->bsf", x, w1) + b1
        zero = torch.zeros_like(h)
        r = torch.where(h > zero, h, zero)
        h = r * r
        out = torch.einsum("bsf,fd->bsd", h, w2) + b2
        return out

    x = A_x
    xn = _layernorm(x, axis=-1)
    s = _A_ref(xn, A_k_cache, A_v_cache, A_wq, A_wo)
    g = _silu(_B_ref(xn, B_w1, B_b1, B_w2, B_b2))
    return x + s * g
```

```asm
; @launch grid=(256,1,1) block=(512,1,1) lds=10240
.amdgcn_target "amdgcn-amd-amdhsa--gfx950"
.text
.globl recurrent_scan__mha_block_cached__dense_activation_squared_relu__decode_kernel
.p2align 8
.type recurrent_scan__mha_block_cached__dense_activation_squared_relu__decode_kernel,@function
recurrent_scan__mha_block_cached__dense_activation_squared_relu__decode_kernel:
  s_cmp_ge_u32 s2, 256
  s_cbranch_scc1 L_end
  s_load_dwordx16 s[8:23], s[0:1], 0
  s_load_dwordx8 s[24:31], s[0:1], 64
  s_load_dwordx2 s[32:33], s[0:1], 96
  v_lshrrev_b32 v1, 6, v0
  v_and_b32 v0, 63, v0
  v_readfirstlane_b32 s3, v1
  s_lshr_b32 s34, s2, 3
  s_and_b32 s35, s2, 7
  s_mov_b32 s5, s3
  s_cmp_eq_u32 s3, 3
  s_cbranch_scc0 L_nopf
  s_getpc_b64 s[60:61]
L_pc:
  s_sub_u32 s60, s60, L_pc-recurrent_scan__mha_block_cached__dense_activation_squared_relu__decode_kernel
  s_subb_u32 s61, s61, 0
  s_and_b32 s61, s61, 0xffff
  s_mov_b32 s62, L_codeend-recurrent_scan__mha_block_cached__dense_activation_squared_relu__decode_kernel
  s_mov_b32 s63, 0x20000
  s_and_b32 s36, s34, 3
  s_mul_i32 s36, s36, 5120
  v_lshlrev_b32 v13, 4, v0
  buffer_load_dwordx4 v[40:43], v13, s[60:63], s36 offen offset:0
  buffer_load_dwordx4 v[40:43], v13, s[60:63], s36 offen offset:1024
  buffer_load_dwordx4 v[40:43], v13, s[60:63], s36 offen offset:2048
  buffer_load_dwordx4 v[40:43], v13, s[60:63], s36 offen offset:3072
  s_add_u32 s36, s36, 4096
  buffer_load_dwordx4 v[40:43], v13, s[60:63], s36 offen
L_nopf:
  s_cmp_ge_u32 s3, 4
  s_cbranch_scc1 L_stream
L_aux:
  s_setprio 3
  s_mov_b32 s100, 524288
  s_mov_b32 s101, 0
  v_lshrrev_b32 v10, 4, v0
  v_bfe_u32 v11, v0, 3, 1
  v_and_b32 v12, 15, v0
  s_cmp_ge_u32 s3, 2
  s_cbranch_scc1 L_aux23
  s_cmp_eq_u32 s3, 1
  s_cbranch_scc1 L_p1
  s_mul_i32 s36, s35, 72
  s_mov_b32 s37, 18
  s_mov_b32 s38, 8192
  s_lshl_b32 s39, s34, 8
  s_mul_i32 s40, s36, 8192
  s_add_u32 s39, s39, s40
  s_sub_u32 s54, 4718592, s39
  s_mov_b32 s41, 99
  s_mov_b32 s42, 1
  s_mov_b32 s43, 14
  s_branch L_p2
L_p1:
  s_mul_hi_u32 s43, s2, 0x71c71c8
  s_mul_i32 s44, s43, 36
  s_sub_u32 s44, s2, s44
  s_mul_i32 s36, s43, 82
  s_cmp_eq_u32 s43, 0
  s_cselect_b32 s40, 0, 2
  s_cselect_b32 s41, 99, 3
  s_add_u32 s36, s36, s40
  s_mov_b32 s37, 22
  s_mov_b32 s38, 9216
  s_lshl_b32 s39, s44, 8
  s_mul_i32 s40, s36, 9216
  s_add_u32 s39, s39, s40
  s_sub_u32 s54, 5308416, s39
  s_mov_b32 s42, 0
  s_cmp_ge_u32 s2, 252
  s_cselect_b32 s54, 0, s54
L_p2:
  v_lshrrev_b32 v13, 5, v0
  v_mul_u32_u24 v13, 1152, v13
  v_and_b32 v14, 31, v0
  v_mad_u32_u24 v13, v14, 36, v13
  v_mul_lo_u32 v14, v10, s37
  v_add_u32 v15, s36, v14
  v_lshlrev_b32 v15, 1, v15
  v_mul_u32_u24 v16, 1152, v11
  v_add_u32 v15, v15, v16
  v_mul_lo_u32 v16, v14, s38
  v_lshl_add_u32 v16, v12, 4, v16
  v_mov_b32 v19, 1073741824
  v_cmp_eq_u32 vcc, s41, v10
  s_nop 1
  v_cndmask_b32 v17, v16, v19, vcc
  v_cmp_eq_u32 vcc, 3, v10
  s_nop 1
  v_cndmask_b32 v18, v16, v19, vcc
  s_cmp_eq_u32 s42, 1
  s_cselect_b64 vcc, -1, 0
  v_cndmask_b32 v18, v18, v19, vcc
  s_mov_b32 s62, 2304
  s_mov_b32 s63, 0x20000
  s_mov_b32 s55, 0x20000
  s_waitcnt lgkmcnt(0)
  s_load_dwordx2 s[46:47], s[32:33], 0
  s_mov_b32 s60, s8
  s_and_b32 s61, s9, 0xffff
  buffer_load_dwordx4 v[20:23], v13, s[60:63], 0 offen
  buffer_load_dwordx4 v[24:27], v13, s[60:63], 0 offen offset:16
  buffer_load_dword v28, v13, s[60:63], 0 offen offset:32
  buffer_load_dwordx4 v[30:33], v15, s[60:63], 0 offen
  buffer_load_dwordx4 v[34:37], v15, s[60:63], 0 offen offset:16
  buffer_load_dwordx3 v[38:40], v15, s[60:63], 0 offen offset:32
  s_cmp_eq_u32 s3, 1
  s_cselect_b32 s52, s20, s14
  s_cselect_b32 s53, s21, s15
  s_add_u32 s52, s52, s39
  s_addc_u32 s53, s53, 0
  s_and_b32 s53, s53, 0xffff
  s_mov_b32 s45, 0
  buffer_load_dwordx4 a[0:3], v16, s[52:55], s45 offen nt
  s_add_u32 s45, s45, s38
  buffer_load_dwordx4 a[4:7], v16, s[52:55], s45 offen nt
  s_add_u32 s45, s45, s38
  buffer_load_dwordx4 a[8:11], v16, s[52:55], s45 offen nt
  s_add_u32 s45, s45, s38
  buffer_load_dwordx4 a[12:15], v16, s[52:55], s45 offen nt
  s_add_u32 s45, s45, s38
  buffer_load_dwordx4 a[16:19], v16, s[52:55], s45 offen nt
  s_add_u32 s45, s45, s38
  buffer_load_dwordx4 a[20:23], v16, s[52:55], s45 offen nt
  s_add_u32 s45, s45, s38
  buffer_load_dwordx4 a[24:27], v16, s[52:55], s45 offen nt
  s_add_u32 s45, s45, s38
  buffer_load_dwordx4 a[28:31], v16, s[52:55], s45 offen nt
  s_add_u32 s45, s45, s38
  buffer_load_dwordx4 a[32:35], v16, s[52:55], s45 offen nt
  s_add_u32 s45, s45, s38
  buffer_load_dwordx4 a[36:39], v16, s[52:55], s45 offen nt
  s_add_u32 s45, s45, s38
  buffer_load_dwordx4 a[40:43], v16, s[52:55], s45 offen nt
  s_add_u32 s45, s45, s38
  buffer_load_dwordx4 a[44:47], v16, s[52:55], s45 offen nt
  s_add_u32 s45, s45, s38
  buffer_load_dwordx4 a[48:51], v16, s[52:55], s45 offen nt
  s_add_u32 s45, s45, s38
  buffer_load_dwordx4 a[52:55], v16, s[52:55], s45 offen nt
  s_add_u32 s45, s45, s38
  buffer_load_dwordx4 a[56:59], v16, s[52:55], s45 offen nt
  s_add_u32 s45, s45, s38
  buffer_load_dwordx4 a[60:63], v16, s[52:55], s45 offen nt
  s_add_u32 s45, s45, s38
  buffer_load_dwordx4 a[64:67], v17, s[52:55], s45 offen nt
  s_add_u32 s45, s45, s38
  buffer_load_dwordx4 a[68:71], v17, s[52:55], s45 offen nt
  s_add_u32 s45, s45, s38
  buffer_load_dwordx4 a[72:75], v18, s[52:55], s45 offen nt
  s_add_u32 s45, s45, s38
  buffer_load_dwordx4 a[76:79], v18, s[52:55], s45 offen nt
  s_add_u32 s45, s45, s38
  buffer_load_dwordx4 a[80:83], v18, s[52:55], s45 offen nt
  s_add_u32 s45, s45, s38
  buffer_load_dwordx4 a[84:87], v18, s[52:55], s45 offen nt
  s_barrier
  s_mov_b32 s48, s32
  s_and_b32 s49, s33, 0xffff
  s_mov_b32 s50, 5242880
  s_mov_b32 s51, 0x20000
  v_and_b32 v1, 1, v0
  v_lshlrev_b32 v1, 4, v1
  v_mov_b32 v2, 0xffff
  v_lshlrev_b32 v1, v1, v2
  v_bfe_u32 v2, v0, 1, 2
  v_cmp_eq_u32 vcc, 0, v2
  s_nop 1
  v_cndmask_b32 v6, 0, v1, vcc
  v_cmp_eq_u32 vcc, 1, v2
  s_nop 1
  v_cndmask_b32 v7, 0, v1, vcc
  v_cmp_eq_u32 vcc, 2, v2
  s_nop 1
  v_cndmask_b32 v8, 0, v1, vcc
  v_cmp_eq_u32 vcc, 3, v2
  s_nop 1
  v_cndmask_b32 v9, 0, v1, vcc
  v_lshlrev_b32 v41, 2, v0
  v_mov_b32 v42, 0
  s_lshl_b32 s40, s34, 8
  s_add_u32 s40, s40, 983040
  s_add_u32 s56, s32, s40
  s_addc_u32 s57, s33, 0
  s_and_b32 s57, s57, 0xffff
  s_mov_b32 s59, 0x20000
  s_or_b32 s40, s35, s3
  s_cmp_eq_u32 s40, 0
  s_cselect_b32 s58, 4, 0
  buffer_store_dword v42, v41, s[56:59], 0 offen sc1
  s_waitcnt vmcnt(25)
  v_lshlrev_b32 v44, 16, v20
  v_and_b32 v45, 0xffff0000, v20
  v_lshlrev_b32 v46, 16, v21
  v_and_b32 v47, 0xffff0000, v21
  v_lshlrev_b32 v48, 16, v22
  v_and_b32 v49, 0xffff0000, v22
  v_lshlrev_b32 v50, 16, v23
  v_and_b32 v51, 0xffff0000, v23
  v_lshlrev_b32 v52, 16, v24
  v_and_b32 v53, 0xffff0000, v24
  v_lshlrev_b32 v54, 16, v25
  v_and_b32 v55, 0xffff0000, v25
  v_lshlrev_b32 v56, 16, v26
  v_and_b32 v57, 0xffff0000, v26
  v_lshlrev_b32 v58, 16, v27
  v_and_b32 v59, 0xffff0000, v27
  v_lshlrev_b32 v60, 16, v28
  v_and_b32 v61, 0xffff0000, v28
  v_pk_add_f32 v[62:63], v[44:45], v[46:47]
  v_pk_add_f32 v[62:63], v[62:63], v[48:49]
  v_pk_add_f32 v[62:63], v[62:63], v[50:51]
  v_pk_add_f32 v[62:63], v[62:63], v[52:53]
  v_pk_add_f32 v[62:63], v[62:63], v[54:55]
  v_pk_add_f32 v[62:63], v[62:63], v[56:57]
  v_pk_add_f32 v[62:63], v[62:63], v[58:59]
  v_pk_add_f32 v[62:63], v[62:63], v[60:61]
  v_add_f32 v62, v62, v63
  s_nop 1
  v_add_f32_dpp v62, v62, v62 row_ror:8 row_mask:0xf bank_mask:0xf
  s_nop 1
  v_add_f32_dpp v62, v62, v62 row_ror:4 row_mask:0xf bank_mask:0xf
  s_nop 1
  v_add_f32_dpp v62, v62, v62 row_ror:2 row_mask:0xf bank_mask:0xf
  s_nop 1
  v_add_f32_dpp v62, v62, v62 row_ror:1 row_mask:0xf bank_mask:0xf
  v_mov_b32 v63, v62
  s_nop 1
  v_permlane16_swap_b32 v62, v63
  v_add_f32 v62, v62, v63
  v_mul_f32 v62, 0x3ae38e39, v62
  v_mov_b32 v63, v62
  v_pk_add_f32 v[44:45], v[44:45], v[62:63] neg_lo:[0,1] neg_hi:[0,1]
  v_pk_add_f32 v[46:47], v[46:47], v[62:63] neg_lo:[0,1] neg_hi:[0,1]
  v_pk_add_f32 v[48:49], v[48:49], v[62:63] neg_lo:[0,1] neg_hi:[0,1]
  v_pk_add_f32 v[50:51], v[50:51], v[62:63] neg_lo:[0,1] neg_hi:[0,1]
  v_pk_add_f32 v[52:53], v[52:53], v[62:63] neg_lo:[0,1] neg_hi:[0,1]
  v_pk_add_f32 v[54:55], v[54:55], v[62:63] neg_lo:[0,1] neg_hi:[0,1]
  v_pk_add_f32 v[56:57], v[56:57], v[62:63] neg_lo:[0,1] neg_hi:[0,1]
  v_pk_add_f32 v[58:59], v[58:59], v[62:63] neg_lo:[0,1] neg_hi:[0,1]
  v_pk_add_f32 v[60:61], v[60:61], v[62:63] neg_lo:[0,1] neg_hi:[0,1]
  v_pk_mul_f32 v[64:65], v[44:45], v[44:45]
  v_pk_fma_f32 v[64:65], v[46:47], v[46:47], v[64:65]
  v_pk_fma_f32 v[64:65], v[48:49], v[48:49], v[64:65]
  v_pk_fma_f32 v[64:65], v[50:51], v[50:51], v[64:65]
  v_pk_fma_f32 v[64:65], v[52:53], v[52:53], v[64:65]
  v_pk_fma_f32 v[64:65], v[54:55], v[54:55], v[64:65]
  v_pk_fma_f32 v[64:65], v[56:57], v[56:57], v[64:65]
  v_pk_fma_f32 v[64:65], v[58:59], v[58:59], v[64:65]
  v_pk_fma_f32 v[64:65], v[60:61], v[60:61], v[64:65]
  v_add_f32 v64, v64, v65
  s_nop 1
  v_add_f32_dpp v64, v64, v64 row_ror:8 row_mask:0xf bank_mask:0xf
  s_nop 1
  v_add_f32_dpp v64, v64, v64 row_ror:4 row_mask:0xf bank_mask:0xf
  s_nop 1
  v_add_f32_dpp v64, v64, v64 row_ror:2 row_mask:0xf bank_mask:0xf
  s_nop 1
  v_add_f32_dpp v64, v64, v64 row_ror:1 row_mask:0xf bank_mask:0xf
  v_mov_b32 v65, v64
  s_nop 1
  v_permlane16_swap_b32 v64, v65
  v_add_f32 v64, v64, v65
  v_mul_f32 v64, 0x3ae38e39, v64
  v_cvt_pk_bf16_f32 v62, v62, v62
  v_and_b32 v62, 0xffff0000, v62
  v_cvt_pk_bf16_f32 v64, v64, v64
  v_and_b32 v64, 0xffff0000, v64
  v_add_f32 v64, 0x3727c5ac, v64
  v_cvt_pk_bf16_f32 v64, v64, v64
  v_and_b32 v64, 0xffff0000, v64
  v_sqrt_f32 v64, v64
  s_nop 0
  v_cvt_pk_bf16_f32 v64, v64, v64
  v_and_b32 v64, 0xffff0000, v64
  v_rcp_f32 v64, v64
  v_readlane_b32 s56, v62, 0
  v_readlane_b32 s57, v62, 32
  v_readlane_b32 s58, v64, 0
  v_readlane_b32 s59, v64, 32
  v_cmp_eq_u32 vcc, 1, v11
  v_mov_b32 v62, s56
  v_mov_b32 v63, s57
  v_cndmask_b32 v62, v62, v63, vcc
  v_mov_b32 v64, s58
  v_mov_b32 v65, s59
  v_cndmask_b32 v64, v64, v65, vcc
  v_mov_b32 v63, v62
  v_mov_b32 v65, v64
  s_waitcnt vmcnt(22)
  v_lshlrev_b32 v66, 16, v30
  v_and_b32 v67, 0xffff0000, v30
  v_pk_add_f32 v[66:67], v[66:67], v[62:63] neg_lo:[0,1] neg_hi:[0,1]
  v_cvt_pk_bf16_f32 v68, v66, v67
  v_lshlrev_b32 v66, 16, v68
  v_and_b32 v67, 0xffff0000, v68
  v_pk_mul_f32 v[66:67], v[66:67], v[64:65]
  v_cvt_pk_bf16_f32 v30, v66, v67
  v_lshlrev_b32 v66, 16, v31
  v_and_b32 v67, 0xffff0000, v31
  v_pk_add_f32 v[66:67], v[66:67], v[62:63] neg_lo:[0,1] neg_hi:[0,1]
  v_cvt_pk_bf16_f32 v68, v66, v67
  v_lshlrev_b32 v66, 16, v68
  v_and_b32 v67, 0xffff0000, v68
  v_pk_mul_f32 v[66:67], v[66:67], v[64:65]
  v_cvt_pk_bf16_f32 v31, v66, v67
  v_lshlrev_b32 v66, 16, v32
  v_and_b32 v67, 0xffff0000, v32
  v_pk_add_f32 v[66:67], v[66:67], v[62:63] neg_lo:[0,1] neg_hi:[0,1]
  v_cvt_pk_bf16_f32 v68, v66, v67
  v_lshlrev_b32 v66, 16, v68
  v_and_b32 v67, 0xffff0000, v68
  v_pk_mul_f32 v[66:67], v[66:67], v[64:65]
  v_cvt_pk_bf16_f32 v32, v66, v67
  v_lshlrev_b32 v66, 16, v33
  v_and_b32 v67, 0xffff0000, v33
  v_pk_add_f32 v[66:67], v[66:67], v[62:63] neg_lo:[0,1] neg_hi:[0,1]
  v_cvt_pk_bf16_f32 v68, v66, v67
  v_lshlrev_b32 v66, 16, v68
  v_and_b32 v67, 0xffff0000, v68
  v_pk_mul_f32 v[66:67], v[66:67], v[64:65]
  v_cvt_pk_bf16_f32 v33, v66, v67
  v_lshlrev_b32 v66, 16, v34
  v_and_b32 v67, 0xffff0000, v34
  v_pk_add_f32 v[66:67], v[66:67], v[62:63] neg_lo:[0,1] neg_hi:[0,1]
  v_cvt_pk_bf16_f32 v68, v66, v67
  v_lshlrev_b32 v66, 16, v68
  v_and_b32 v67, 0xffff0000, v68
  v_pk_mul_f32 v[66:67], v[66:67], v[64:65]
  v_cvt_pk_bf16_f32 v34, v66, v67
  v_lshlrev_b32 v66, 16, v35
  v_and_b32 v67, 0xffff0000, v35
  v_pk_add_f32 v[66:67], v[66:67], v[62:63] neg_lo:[0,1] neg_hi:[0,1]
  v_cvt_pk_bf16_f32 v68, v66, v67
  v_lshlrev_b32 v66, 16, v68
  v_and_b32 v67, 0xffff0000, v68
  v_pk_mul_f32 v[66:67], v[66:67], v[64:65]
  v_cvt_pk_bf16_f32 v35, v66, v67
  v_lshlrev_b32 v66, 16, v36
  v_and_b32 v67, 0xffff0000, v36
  v_pk_add_f32 v[66:67], v[66:67], v[62:63] neg_lo:[0,1] neg_hi:[0,1]
  v_cvt_pk_bf16_f32 v68, v66, v67
  v_lshlrev_b32 v66, 16, v68
  v_and_b32 v67, 0xffff0000, v68
  v_pk_mul_f32 v[66:67], v[66:67], v[64:65]
  v_cvt_pk_bf16_f32 v36, v66, v67
  v_lshlrev_b32 v66, 16, v37
  v_and_b32 v67, 0xffff0000, v37
  v_pk_add_f32 v[66:67], v[66:67], v[62:63] neg_lo:[0,1] neg_hi:[0,1]
  v_cvt_pk_bf16_f32 v68, v66, v67
  v_lshlrev_b32 v66, 16, v68
  v_and_b32 v67, 0xffff0000, v68
  v_pk_mul_f32 v[66:67], v[66:67], v[64:65]
  v_cvt_pk_bf16_f32 v37, v66, v67
  v_lshlrev_b32 v66, 16, v38
  v_and_b32 v67, 0xffff0000, v38
  v_pk_add_f32 v[66:67], v[66:67], v[62:63] neg_lo:[0,1] neg_hi:[0,1]
  v_cvt_pk_bf16_f32 v68, v66, v67
  v_lshlrev_b32 v66, 16, v68
  v_and_b32 v67, 0xffff0000, v68
  v_pk_mul_f32 v[66:67], v[66:67], v[64:65]
  v_cvt_pk_bf16_f32 v38, v66, v67
  v_lshlrev_b32 v66, 16, v39
  v_and_b32 v67, 0xffff0000, v39
  v_pk_add_f32 v[66:67], v[66:67], v[62:63] neg_lo:[0,1] neg_hi:[0,1]
  v_cvt_pk_bf16_f32 v68, v66, v67
  v_lshlrev_b32 v66, 16, v68
  v_and_b32 v67, 0xffff0000, v68
  v_pk_mul_f32 v[66:67], v[66:67], v[64:65]
  v_cvt_pk_bf16_f32 v39, v66, v67
  v_lshlrev_b32 v66, 16, v40
  v_and_b32 v67, 0xffff0000, v40
  v_pk_add_f32 v[66:67], v[66:67], v[62:63] neg_lo:[0,1] neg_hi:[0,1]
  v_cvt_pk_bf16_f32 v68, v66, v67
  v_lshlrev_b32 v66, 16, v68
  v_and_b32 v67, 0xffff0000, v68
  v_pk_mul_f32 v[66:67], v[66:67], v[64:65]
  v_cvt_pk_bf16_f32 v40, v66, v67
  s_mov_b32 s56, 0x01000100
  s_mov_b32 s57, 0x03020302
  v_mov_b32 v70, 0
  v_mov_b32 v71, 0
  v_mov_b32 v72, 0
  v_mov_b32 v73, 0
  v_perm_b32 v74, v30, v30, s56
  v_and_b32 v76, v74, v6
  v_and_b32 v77, v74, v7
  v_and_b32 v78, v74, v8
  v_and_b32 v79, v74, v9
  s_waitcnt vmcnt(21)
  s_nop 0
  v_mfma_f32_16x16x32_bf16 v[70:73], a[0:3], v[76:79], v[70:73]
  v_perm_b32 v74, v30, v30, s57
  v_and_b32 v80, v74, v6
  v_and_b32 v81, v74, v7
  v_and_b32 v82, v74, v8
  v_and_b32 v83, v74, v9
  s_waitcnt vmcnt(20)
  s_nop 0
  v_mfma_f32_16x16x32_bf16 v[70:73], a[4:7], v[80:83], v[70:73]
  v_perm_b32 v74, v31, v31, s56
  v_and_b32 v76, v74, v6
  v_and_b32 v77, v74, v7
  v_and_b32 v78, v74, v8
  v_and_b32 v79, v74, v9
  s_waitcnt vmcnt(19)
  s_nop 0
  v_mfma_f32_16x16x32_bf16 v[70:73], a[8:11], v[76:79], v[70:73]
  v_perm_b32 v74, v31, v31, s57
  v_and_b32 v80, v74, v6
  v_and_b32 v81, v74, v7
  v_and_b32 v82, v74, v8
  v_and_b32 v83, v74, v9
  s_waitcnt vmcnt(18)
  s_nop 0
  v_mfma_f32_16x16x32_bf16 v[70:73], a[12:15], v[80:83], v[70:73]
  v_perm_b32 v74, v32, v32, s56
  v_and_b32 v76, v74, v6
  v_and_b32 v77, v74, v7
  v_and_b32 v78, v74, v8
  v_and_b32 v79, v74, v9
  s_waitcnt vmcnt(17)
  s_nop 0
  v_mfma_f32_16x16x32_bf16 v[70:73], a[16:19], v[76:79], v[70:73]
  v_perm_b32 v74, v32, v32, s57
  v_and_b32 v80, v74, v6
  v_and_b32 v81, v74, v7
  v_and_b32 v82, v74, v8
  v_and_b32 v83, v74, v9
  s_waitcnt vmcnt(16)
  s_nop 0
  v_mfma_f32_16x16x32_bf16 v[70:73], a[20:23], v[80:83], v[70:73]
  v_perm_b32 v74, v33, v33, s56
  v_and_b32 v76, v74, v6
  v_and_b32 v77, v74, v7
  v_and_b32 v78, v74, v8
  v_and_b32 v79, v74, v9
  s_waitcnt vmcnt(15)
  s_nop 0
  v_mfma_f32_16x16x32_bf16 v[70:73], a[24:27], v[76:79], v[70:73]
  v_perm_b32 v74, v33, v33, s57
  v_and_b32 v80, v74, v6
  v_and_b32 v81, v74, v7
  v_and_b32 v82, v74, v8
  v_and_b32 v83, v74, v9
  s_waitcnt vmcnt(14)
  s_nop 0
  v_mfma_f32_16x16x32_bf16 v[70:73], a[28:31], v[80:83], v[70:73]
  v_perm_b32 v74, v34, v34, s56
  v_and_b32 v76, v74, v6
  v_and_b32 v77, v74, v7
  v_and_b32 v78, v74, v8
  v_and_b32 v79, v74, v9
  s_waitcnt vmcnt(13)
  s_nop 0
  v_mfma_f32_16x16x32_bf16 v[70:73], a[32:35], v[76:79], v[70:73]
  v_perm_b32 v74, v34, v34, s57
  v_and_b32 v80, v74, v6
  v_and_b32 v81, v74, v7
  v_and_b32 v82, v74, v8
  v_and_b32 v83, v74, v9
  s_waitcnt vmcnt(12)
  s_nop 0
  v_mfma_f32_16x16x32_bf16 v[70:73], a[36:39], v[80:83], v[70:73]
  v_perm_b32 v74, v35, v35, s56
  v_and_b32 v76, v74, v6
  v_and_b32 v77, v74, v7
  v_and_b32 v78, v74, v8
  v_and_b32 v79, v74, v9
  s_waitcnt vmcnt(11)
  s_nop 0
  v_mfma_f32_16x16x32_bf16 v[70:73], a[40:43], v[76:79], v[70:73]
  v_perm_b32 v74, v35, v35, s57
  v_and_b32 v80, v74, v6
  v_and_b32 v81, v74, v7
  v_and_b32 v82, v74, v8
  v_and_b32 v83, v74, v9
  s_waitcnt vmcnt(10)
  s_nop 0
  v_mfma_f32_16x16x32_bf16 v[70:73], a[44:47], v[80:83], v[70:73]
  v_perm_b32 v74, v36, v36, s56
  v_and_b32 v76, v74, v6
  v_and_b32 v77, v74, v7
  v_and_b32 v78, v74, v8
  v_and_b32 v79, v74, v9
  s_waitcnt vmcnt(9)
  s_nop 0
  v_mfma_f32_16x16x32_bf16 v[70:73], a[48:51], v[76:79], v[70:73]
  v_perm_b32 v74, v36, v36, s57
  v_and_b32 v80, v74, v6
  v_and_b32 v81, v74, v7
  v_and_b32 v82, v74, v8
  v_and_b32 v83, v74, v9
  s_waitcnt vmcnt(8)
  s_nop 0
  v_mfma_f32_16x16x32_bf16 v[70:73], a[52:55], v[80:83], v[70:73]
  v_perm_b32 v74, v37, v37, s56
  v_and_b32 v76, v74, v6
  v_and_b32 v77, v74, v7
  v_and_b32 v78, v74, v8
  v_and_b32 v79, v74, v9
  s_waitcnt vmcnt(7)
  s_nop 0
  v_mfma_f32_16x16x32_bf16 v[70:73], a[56:59], v[76:79], v[70:73]
  v_perm_b32 v74, v37, v37, s57
  v_and_b32 v80, v74, v6
  v_and_b32 v81, v74, v7
  v_and_b32 v82, v74, v8
  v_and_b32 v83, v74, v9
  s_waitcnt vmcnt(6)
  s_nop 0
  v_mfma_f32_16x16x32_bf16 v[70:73], a[60:63], v[80:83], v[70:73]
  v_perm_b32 v74, v38, v38, s56
  v_and_b32 v76, v74, v6
  v_and_b32 v77, v74, v7
  v_and_b32 v78, v74, v8
  v_and_b32 v79, v74, v9
  s_waitcnt vmcnt(5)
  s_nop 0
  v_mfma_f32_16x16x32_bf16 v[70:73], a[64:67], v[76:79], v[70:73]
  v_perm_b32 v74, v38, v38, s57
  v_and_b32 v80, v74, v6
  v_and_b32 v81, v74, v7
  v_and_b32 v82, v74, v8
  v_and_b32 v83, v74, v9
  s_waitcnt vmcnt(4)
  s_nop 0
  v_mfma_f32_16x16x32_bf16 v[70:73], a[68:71], v[80:83], v[70:73]
  v_perm_b32 v74, v39, v39, s56
  v_and_b32 v76, v74, v6
  v_and_b32 v77, v74, v7
  v_and_b32 v78, v74, v8
  v_and_b32 v79, v74, v9
  s_waitcnt vmcnt(3)
  s_nop 0
  v_mfma_f32_16x16x32_bf16 v[70:73], a[72:75], v[76:79], v[70:73]
  v_perm_b32 v74, v39, v39, s57
  v_and_b32 v80, v74, v6
  v_and_b32 v81, v74, v7
  v_and_b32 v82, v74, v8
  v_and_b32 v83, v74, v9
  s_waitcnt vmcnt(2)
  s_nop 0
  v_mfma_f32_16x16x32_bf16 v[70:73], a[76:79], v[80:83], v[70:73]
  v_perm_b32 v74, v40, v40, s56
  v_and_b32 v76, v74, v6
  v_and_b32 v77, v74, v7
  v_and_b32 v78, v74, v8
  v_and_b32 v79, v74, v9
  s_waitcnt vmcnt(1)
  s_nop 0
  v_mfma_f32_16x16x32_bf16 v[70:73], a[80:83], v[76:79], v[70:73]
  v_perm_b32 v74, v40, v40, s57
  v_and_b32 v80, v74, v6
  v_and_b32 v81, v74, v7
  v_and_b32 v82, v74, v8
  v_and_b32 v83, v74, v9
  s_waitcnt vmcnt(0)
  s_nop 0
  v_mfma_f32_16x16x32_bf16 v[70:73], a[84:87], v[80:83], v[70:73]
  s_waitcnt lgkmcnt(0)
  s_add_u32 s46, s46, 0x7f4a7c15
  s_addc_u32 s47, s47, 0x9e3779b9
  s_and_b32 s44, s46, 1023
  v_mov_b32 v2, s44
  s_bfe_u32 s44, s46, 0xa000a
  v_mov_b32 v3, s44
  s_bfe_u32 s44, s46, 0xa0014
  v_mov_b32 v4, s44
  s_lshr_b64 s[56:57], s[46:47], 30
  s_and_b32 s44, s56, 1023
  v_mov_b32 v5, s44
  s_mov_b32 s44, 1023
  s_mov_b32 s45, 0xfffffc00
  s_cmp_eq_u32 s3, 1
  s_cbranch_scc1 L_hpub
  s_mov_b32 s4, 524288
  v_mov_b32 v20, 532
L_poll0:
  ds_read_b32 v21, v20
  s_waitcnt lgkmcnt(0)
  v_readfirstlane_b32 s6, v21
  s_cmp_ge_u32 s6, 3
  s_cbranch_scc1 L_pdone0
  s_sub_u32 s4, s4, 1
  s_cmp_lg_u32 s4, 0
  s_cbranch_scc1 L_poll0
L_pdone0:
  s_waitcnt vmcnt(0)
  v_add_u32 v74, 512, v70
  v_add_u32 v75, 512, v71
  v_add_u32 v76, 512, v72
  v_add_u32 v77, 512, v73
  v_bfi_b32 v74, s44, v2, v74
  v_bfi_b32 v75, s44, v3, v75
  v_bfi_b32 v76, s44, v4, v76
  v_bfi_b32 v77, s44, v5, v77
  v_lshlrev_b32 v13, 4, v0
  s_lshl_b32 s36, s2, 10
  s_add_u32 s36, s36, 65536
  buffer_store_dwordx4 v[74:77], v13, s[48:51], s36 offen sc1
  v_lshlrev_b32 v13, 4, v0
  s_lshl_b32 s36, s34, 13
  s_add_u32 s36, s36, 65536
  s_add_u32 s37, s36, 4096
  s_mov_b32 s4, s100
L_poll1:
  buffer_load_dwordx4 v[20:23], v13, s[48:51], s36 offen offset:0 sc1
  buffer_load_dwordx4 v[24:27], v13, s[48:51], s36 offen offset:1024 sc1
  buffer_load_dwordx4 v[28:31], v13, s[48:51], s36 offen offset:2048 sc1
  buffer_load_dwordx4 v[32:35], v13, s[48:51], s36 offen offset:3072 sc1
  buffer_load_dwordx4 v[36:39], v13, s[48:51], s37 offen offset:0 sc1
  buffer_load_dwordx4 v[40:43], v13, s[48:51], s37 offen offset:1024 sc1
  buffer_load_dwordx4 v[44:47], v13, s[48:51], s37 offen offset:2048 sc1
  buffer_load_dwordx4 v[48:51], v13, s[48:51], s37 offen offset:3072 sc1
  s_waitcnt vmcnt(0)
  v_xor_b32 v52, v20, v2
  v_bitop3_b32 v52, v21, v3, v52 bitop3:0xbe
  v_bitop3_b32 v52, v22, v4, v52 bitop3:0xbe
  v_bitop3_b32 v52, v23, v5, v52 bitop3:0xbe
  v_bitop3_b32 v52, v24, v2, v52 bitop3:0xbe
  v_bitop3_b32 v52, v25, v3, v52 bitop3:0xbe
  v_bitop3_b32 v52, v26, v4, v52 bitop3:0xbe
  v_bitop3_b32 v52, v27, v5, v52 bitop3:0xbe
  v_bitop3_b32 v52, v28, v2, v52 bitop3:0xbe
  v_bitop3_b32 v52, v29, v3, v52 bitop3:0xbe
  v_bitop3_b32 v52, v30, v4, v52 bitop3:0xbe
  v_bitop3_b32 v52, v31, v5, v52 bitop3:0xbe
  v_bitop3_b32 v52, v32, v2, v52 bitop3:0xbe
  v_bitop3_b32 v52, v33, v3, v52 bitop3:0xbe
  v_bitop3_b32 v52, v34, v4, v52 bitop3:0xbe
  v_bitop3_b32 v52, v35, v5, v52 bitop3:0xbe
  v_bitop3_b32 v52, v36, v2, v52 bitop3:0xbe
  v_bitop3_b32 v52, v37, v3, v52 bitop3:0xbe
  v_bitop3_b32 v52, v38, v4, v52 bitop3:0xbe
  v_bitop3_b32 v52, v39, v5, v52 bitop3:0xbe
  v_bitop3_b32 v52, v40, v2, v52 bitop3:0xbe
  v_bitop3_b32 v52, v41, v3, v52 bitop3:0xbe
  v_bitop3_b32 v52, v42, v4, v52 bitop3:0xbe
  v_bitop3_b32 v52, v43, v5, v52 bitop3:0xbe
  v_bitop3_b32 v52, v44, v2, v52 bitop3:0xbe
  v_bitop3_b32 v52, v45, v3, v52 bitop3:0xbe
  v_bitop3_b32 v52, v46, v4, v52 bitop3:0xbe
  v_bitop3_b32 v52, v47, v5, v52 bitop3:0xbe
  v_bitop3_b32 v52, v48, v2, v52 bitop3:0xbe
  v_bitop3_b32 v52, v49, v3, v52 bitop3:0xbe
  v_bitop3_b32 v52, v50, v4, v52 bitop3:0xbe
  v_bitop3_b32 v52, v51, v5, v52 bitop3:0xbe
  v_and_b32 v52, s44, v52
  v_cmp_eq_u32 vcc, 0, v52
  s_cmp_eq_u64 vcc, exec
  s_cbranch_scc1 L_pdone1
  s_sleep 1
  s_sub_u32 s4, s4, 1
  s_cmp_lg_u32 s4, 0
  s_cbranch_scc1 L_poll1
L_pdone1:
  v_and_b32 v20, s45, v20
  v_and_b32 v24, s45, v24
  v_and_b32 v28, s45, v28
  v_and_b32 v32, s45, v32
  v_and_b32 v36, s45, v36
  v_and_b32 v40, s45, v40
  v_and_b32 v44, s45, v44
  v_and_b32 v48, s45, v48
  v_add_f32 v20, v20, v24
  v_add_f32 v28, v28, v32
  v_add_f32 v36, v36, v40
  v_add_f32 v44, v44, v48
  v_add_f32 v20, v20, v28
  v_add_f32 v36, v36, v44
  v_add_f32 v20, v20, v36
  v_and_b32 v21, s45, v21
  v_and_b32 v25, s45, v25
  v_and_b32 v29, s45, v29
  v_and_b32 v33, s45, v33
  v_and_b32 v37, s45, v37
  v_and_b32 v41, s45, v41
  v_and_b32 v45, s45, v45
  v_and_b32 v49, s45, v49
  v_add_f32 v21, v21, v25
  v_add_f32 v29, v29, v33
  v_add_f32 v37, v37, v41
  v_add_f32 v45, v45, v49
  v_add_f32 v21, v21, v29
  v_add_f32 v37, v37, v45
  v_add_f32 v21, v21, v37
  v_and_b32 v22, s45, v22
  v_and_b32 v26, s45, v26
  v_and_b32 v30, s45, v30
  v_and_b32 v34, s45, v34
  v_and_b32 v38, s45, v38
  v_and_b32 v42, s45, v42
  v_and_b32 v46, s45, v46
  v_and_b32 v50, s45, v50
  v_add_f32 v22, v22, v26
  v_add_f32 v30, v30, v34
  v_add_f32 v38, v38, v42
  v_add_f32 v46, v46, v50
  v_add_f32 v22, v22, v30
  v_add_f32 v38, v38, v46
  v_add_f32 v22, v22, v38
  v_and_b32 v23, s45, v23
  v_and_b32 v27, s45, v27
  v_and_b32 v31, s45, v31
  v_and_b32 v35, s45, v35
  v_and_b32 v39, s45, v39
  v_and_b32 v43, s45, v43
  v_and_b32 v47, s45, v47
  v_and_b32 v51, s45, v51
  v_add_f32 v23, v23, v27
  v_add_f32 v31, v31, v35
  v_add_f32 v39, v39, v43
  v_add_f32 v47, v47, v51
  v_add_f32 v23, v23, v31
  v_add_f32 v39, v39, v47
  v_add_f32 v23, v23, v39
  v_cvt_pk_bf16_f32 v24, v20, v21
  v_cvt_pk_bf16_f32 v25, v22, v23
  v_lshlrev_b32 v13, 8, v11
  v_lshl_add_u32 v13, v10, 6, v13
  v_and_b32 v14, 7, v0
  v_lshl_add_u32 v13, v14, 1, v13
  ds_write_b16 v13, v24 offset:0
  ds_write_b16_d16_hi v13, v24 offset:16
  ds_write_b16 v13, v25 offset:32
  ds_write_b16_d16_hi v13, v25 offset:48
  s_waitcnt lgkmcnt(0)
  v_mov_b32 v13, 524
  v_mov_b32 v14, 1
  ds_write_b32 v13, v14
  s_branch L_barA
L_hpub:
  s_mov_b64 exec, 1
  v_mov_b32 v13, 532
  v_mov_b32 v14, 1
  ds_add_u32 v13, v14
  s_mov_b64 exec, -1
  s_cmp_ge_u32 s2, 252
  s_cbranch_scc1 L_barA
  v_lshlrev_b32 v13, 9, v11
  v_lshl_add_u32 v13, v10, 7, v13
  v_and_b32 v14, 7, v0
  v_lshl_add_u32 v13, v14, 2, v13
  ds_write_b32 v13, v70 offset:3072
  ds_write_b32 v13, v71 offset:3104
  ds_write_b32 v13, v72 offset:3136
  ds_write_b32 v13, v73 offset:3168
  v_lshlrev_b32 v14, 4, v0
  s_waitcnt lgkmcnt(0)
  ds_read_b128 v[70:73], v14 offset:3072
  v_lshrrev_b32 v13, 5, v0
  v_mul_u32_u24 v13, 18432, v13
  v_and_b32 v14, 31, v0
  v_lshl_add_u32 v13, v14, 4, v13
  s_mul_hi_u32 s43, s2, 0x71c71c8
  s_mul_i32 s36, s43, 36
  s_sub_u32 s36, s2, s36
  s_lshl_b32 s36, s36, 9
  s_mul_i32 s37, s43, 36864
  s_add_u32 s36, s36, s37
  s_add_u32 s36, s36, 393216
  s_waitcnt lgkmcnt(0)
  v_add_u32 v74, 512, v70
  v_add_u32 v75, 512, v71
  v_add_u32 v76, 512, v72
  v_add_u32 v77, 512, v73
  v_bfi_b32 v74, s44, v2, v74
  v_bfi_b32 v75, s44, v3, v75
  v_bfi_b32 v76, s44, v4, v76
  v_bfi_b32 v77, s44, v5, v77
  buffer_store_dwordx4 v[74:77], v13, s[48:51], s36 offen sc1
  s_branch L_barA
L_aux23:
  s_mov_b64 exec, 1
  v_mov_b32 v13, 512
  v_mov_b32 v14, 0
  v_mov_b32 v15, 0
  ds_write_b64 v13, v[14:15]
  ds_write_b64 v13, v[14:15] offset:8
  ds_write_b32 v13, v14 offset:16
  ds_write_b32 v13, v14 offset:20
  s_mov_b64 exec, -1
  v_lshlrev_b32 v13, 2, v0
  v_mov_b32 v14, -1
  ds_write_b32 v13, v14 offset:640
  s_waitcnt lgkmcnt(0)
  s_load_dwordx2 s[46:47], s[32:33], 0
  s_mov_b32 s48, s32
  s_and_b32 s49, s33, 0xffff
  s_mov_b32 s50, 5242880
  s_mov_b32 s51, 0x20000
  s_barrier
  v_and_b32 v1, 1, v0
  v_lshlrev_b32 v1, 4, v1
  v_mov_b32 v2, 0xffff
  v_lshlrev_b32 v1, v1, v2
  v_bfe_u32 v2, v0, 1, 2
  v_cmp_eq_u32 vcc, 0, v2
  s_nop 1
  v_cndmask_b32 v6, 0, v1, vcc
  v_cmp_eq_u32 vcc, 1, v2
  s_nop 1
  v_cndmask_b32 v7, 0, v1, vcc
  v_cmp_eq_u32 vcc, 2, v2
  s_nop 1
  v_cndmask_b32 v8, 0, v1, vcc
  v_cmp_eq_u32 vcc, 3, v2
  s_nop 1
  v_cndmask_b32 v9, 0, v1, vcc
  s_waitcnt lgkmcnt(0)
  s_add_u32 s46, s46, 0x7f4a7c15
  s_addc_u32 s47, s47, 0x9e3779b9
  s_and_b32 s44, s46, 1023
  v_mov_b32 v2, s44
  s_bfe_u32 s44, s46, 0xa000a
  v_mov_b32 v3, s44
  s_bfe_u32 s44, s46, 0xa0014
  v_mov_b32 v4, s44
  s_lshr_b64 s[56:57], s[46:47], 30
  s_and_b32 s44, s56, 1023
  v_mov_b32 v5, s44
  s_mov_b32 s44, 1023
  s_mov_b32 s45, 0xfffffc00
  s_mov_b64 exec, 1
  v_mov_b32 v13, 532
  v_mov_b32 v14, 1
  ds_add_u32 v13, v14
  s_mov_b64 exec, -1
L_barA:
  s_cmp_eq_u32 s3, 0
  s_cbranch_scc0 L_nodisp
  s_lshl_b32 s94, s34, 8
  s_add_u32 s94, s94, 983040
  s_add_u32 s56, s32, s94
  s_addc_u32 s57, s33, 0
  s_and_b32 s57, s57, 0xffff
  s_mov_b32 s58, 4
  s_mov_b32 s59, 0x20000
  v_mov_b32 v13, 0
  v_mov_b32 v14, 520
  s_mov_b32 s90, 0
  s_mov_b32 s4, 4194304
  s_mov_b64 exec, 1
L_dloop:
  ds_read_b32 v15, v14
  s_waitcnt lgkmcnt(0)
  v_readfirstlane_b32 s91, v15
  s_cmp_gt_u32 s91, s90
  s_cbranch_scc1 L_dget
  s_sleep 1
  s_sub_u32 s4, s4, 1
  s_cmp_lg_u32 s4, 0
  s_cbranch_scc1 L_dloop
  s_mov_b32 s92, 256
  s_branch L_dput
L_dget:
  v_mov_b32 v15, 1
  buffer_atomic_add v15, v13, s[56:59], 0 offen sc0 sc1
  s_waitcnt vmcnt(0)
  v_readfirstlane_b32 s91, v15
  s_mov_b32 s92, 256
  s_sub_u32 s93, s91, 0
  s_and_b32 s94, s93, 7
  s_lshl_b32 s94, s94, 1
  s_lshr_b32 s95, s93, 3
  s_mul_i32 s95, s95, 64
  s_add_u32 s94, s94, s95
  s_add_u32 s94, s94, 262272
  s_cmp_lt_u32 s93, 8
  s_cselect_b32 s92, s94, s92
  s_sub_u32 s93, s91, 8
  s_and_b32 s94, s93, 7
  s_lshl_b32 s94, s94, 1
  s_lshr_b32 s95, s93, 3
  s_mul_i32 s95, s95, 32
  s_add_u32 s94, s94, s95
  s_add_u32 s94, s94, 131264
  s_cmp_lt_u32 s93, 8
  s_cselect_b32 s92, s94, s92
  s_sub_u32 s93, s91, 16
  s_and_b32 s94, s93, 7
  s_lshl_b32 s94, s94, 1
  s_lshr_b32 s95, s93, 4
  s_lshl_b32 s95, s95, 4
  s_add_u32 s94, s94, s95
  s_bfe_u32 s95, s93, 0x10003
  s_lshl_b32 s95, s95, 25
  s_add_u32 s94, s94, s95
  s_add_u32 s94, s94, 16842976
  s_cmp_lt_u32 s93, 32
  s_cselect_b32 s92, s94, s92
L_dput:
  s_lshl_b32 s93, s90, 2
  s_add_u32 s93, s93, 640
  v_mov_b32 v15, s93
  v_mov_b32 v16, s92
  ds_write_b32 v15, v16
  s_add_u32 s90, s90, 1
  s_cmp_eq_u32 s92, 256
  s_cbranch_scc0 L_dloop
  s_waitcnt lgkmcnt(0)
  s_mov_b64 exec, -1
L_nodisp:
  s_cmp_eq_u32 s3, 1
  s_cbranch_scc0 L_nodry1
  s_cmp_lt_u32 s2, 36
  s_cbranch_scc0 L_nodry1
  s_mov_b32 s100, 1
  s_mov_b32 s101, 1
  s_mov_b32 s50, 0
  s_branch L_red
L_drydone1:
  s_mov_b32 s100, 524288
  s_mov_b32 s101, 0
  s_mov_b32 s50, 5242880
L_nodry1:
  s_and_b32 s36, s35, 1
  s_lshr_b32 s37, s2, 1
  s_mov_b32 s40, 2
  s_mov_b32 s41, 0
  s_cmp_ge_u32 s3, 2
  s_cbranch_scc1 L_t23
  s_mov_b32 s38, 0
  s_lshl_b32 s39, s36, 1
  s_add_u32 s39, s39, s3
  s_branch L_tdone
L_t23:
  s_mov_b32 s38, 1
  s_lshl_b32 s39, s36, 1
  s_sub_u32 s39, s3, s39
  s_cmp_eq_u32 s3, 2
  s_cbranch_scc0 L_th2
  s_mov_b32 s41, 4
  s_xor_b32 s40, s36, 1
L_th2:
  s_mov_b64 exec, 0x3ffff
  v_cmp_le_u32 vcc, 9, v0
  s_nop 1
  v_cndmask_b32 v13, 0, 1, vcc
  v_mul_u32_u24 v14, 9, v13
  v_sub_u32 v14, v0, v14
  v_mul_u32_u24 v15, 18432, v13
  v_lshl_add_u32 v15, v14, 4, v15
  s_mul_i32 s42, s37, 144
  s_add_u32 s42, s42, 393216
  s_mov_b32 s60, s22
  s_and_b32 s61, s23, 0xffff
  s_mov_b32 s62, 9216
  s_mov_b32 s63, 0x20000
  s_mul_i32 s43, s37, 72
  v_lshlrev_b32 v16, 3, v14
  buffer_load_dwordx2 v[18:19], v16, s[60:63], s43 offen
  s_mov_b64 exec, -1
  s_mov_b32 s4, 524288
  v_mov_b32 v20, 520
L_poll2:
  ds_read_b32 v21, v20
  s_waitcnt lgkmcnt(0)
  v_readfirstlane_b32 s6, v21
  s_cmp_ge_u32 s6, 1
  s_cbranch_scc1 L_pdone2
  s_sleep 1
  s_sub_u32 s4, s4, 1
  s_cmp_lg_u32 s4, 0
  s_cbranch_scc1 L_poll2
L_pdone2:
  s_mov_b64 exec, 0x3ffff
  s_mov_b32 s4, s100
L_poll3:
  s_mov_b32 s43, s42
  buffer_load_dwordx4 v[20:23], v15, s[48:51], s43 offen sc1
  s_add_u32 s43, s43, 36864
  buffer_load_dwordx4 v[24:27], v15, s[48:51], s43 offen sc1
  s_add_u32 s43, s43, 36864
  buffer_load_dwordx4 v[28:31], v15, s[48:51], s43 offen sc1
  s_add_u32 s43, s43, 36864
  buffer_load_dwordx4 v[32:35], v15, s[48:51], s43 offen sc1
  s_add_u32 s43, s43, 36864
  buffer_load_dwordx4 v[36:39], v15, s[48:51], s43 offen sc1
  s_add_u32 s43, s43, 36864
  buffer_load_dwordx4 v[40:43], v15, s[48:51], s43 offen sc1
  s_add_u32 s43, s43, 36864
  buffer_load_dwordx4 v[44:47], v15, s[48:51], s43 offen sc1
  s_waitcnt vmcnt(0)
  v_xor_b32 v48, v20, v2
  v_bitop3_b32 v48, v21, v3, v48 bitop3:0xbe
  v_bitop3_b32 v48, v22, v4, v48 bitop3:0xbe
  v_bitop3_b32 v48, v23, v5, v48 bitop3:0xbe
  v_bitop3_b32 v48, v24, v2, v48 bitop3:0xbe
  v_bitop3_b32 v48, v25, v3, v48 bitop3:0xbe
  v_bitop3_b32 v48, v26, v4, v48 bitop3:0xbe
  v_bitop3_b32 v48, v27, v5, v48 bitop3:0xbe
  v_bitop3_b32 v48, v28, v2, v48 bitop3:0xbe
  v_bitop3_b32 v48, v29, v3, v48 bitop3:0xbe
  v_bitop3_b32 v48, v30, v4, v48 bitop3:0xbe
  v_bitop3_b32 v48, v31, v5, v48 bitop3:0xbe
  v_bitop3_b32 v48, v32, v2, v48 bitop3:0xbe
  v_bitop3_b32 v48, v33, v3, v48 bitop3:0xbe
  v_bitop3_b32 v48, v34, v4, v48 bitop3:0xbe
  v_bitop3_b32 v48, v35, v5, v48 bitop3:0xbe
  v_bitop3_b32 v48, v36, v2, v48 bitop3:0xbe
  v_bitop3_b32 v48, v37, v3, v48 bitop3:0xbe
  v_bitop3_b32 v48, v38, v4, v48 bitop3:0xbe
  v_bitop3_b32 v48, v39, v5, v48 bitop3:0xbe
  v_bitop3_b32 v48, v40, v2, v48 bitop3:0xbe
  v_bitop3_b32 v48, v41, v3, v48 bitop3:0xbe
  v_bitop3_b32 v48, v42, v4, v48 bitop3:0xbe
  v_bitop3_b32 v48, v43, v5, v48 bitop3:0xbe
  v_bitop3_b32 v48, v44, v2, v48 bitop3:0xbe
  v_bitop3_b32 v48, v45, v3, v48 bitop3:0xbe
  v_bitop3_b32 v48, v46, v4, v48 bitop3:0xbe
  v_bitop3_b32 v48, v47, v5, v48 bitop3:0xbe
  v_and_b32 v48, s44, v48
  v_cmp_eq_u32 vcc, 0, v48
  s_cmp_eq_u64 vcc, exec
  s_cbranch_scc1 L_pdone3
  s_sleep 1
  s_sub_u32 s4, s4, 1
  s_cmp_lg_u32 s4, 0
  s_cbranch_scc1 L_poll3
L_pdone3:
  v_and_b32 v20, s45, v20
  v_and_b32 v24, s45, v24
  v_and_b32 v28, s45, v28
  v_and_b32 v32, s45, v32
  v_and_b32 v36, s45, v36
  v_and_b32 v40, s45, v40
  v_and_b32 v44, s45, v44
  v_add_f32 v20, v20, v24
  v_add_f32 v20, v20, v28
  v_add_f32 v20, v20, v32
  v_add_f32 v20, v20, v36
  v_add_f32 v20, v20, v40
  v_add_f32 v20, v20, v44
  v_and_b32 v21, s45, v21
  v_and_b32 v25, s45, v25
  v_and_b32 v29, s45, v29
  v_and_b32 v33, s45, v33
  v_and_b32 v37, s45, v37
  v_and_b32 v41, s45, v41
  v_and_b32 v45, s45, v45
  v_add_f32 v21, v21, v25
  v_add_f32 v21, v21, v29
  v_add_f32 v21, v21, v33
  v_add_f32 v21, v21, v37
  v_add_f32 v21, v21, v41
  v_add_f32 v21, v21, v45
  v_and_b32 v22, s45, v22
  v_and_b32 v26, s45, v26
  v_and_b32 v30, s45, v30
  v_and_b32 v34, s45, v34
  v_and_b32 v38, s45, v38
  v_and_b32 v42, s45, v42
  v_and_b32 v46, s45, v46
  v_add_f32 v22, v22, v26
  v_add_f32 v22, v22, v30
  v_add_f32 v22, v22, v34
  v_add_f32 v22, v22, v38
  v_add_f32 v22, v22, v42
  v_add_f32 v22, v22, v46
  v_and_b32 v23, s45, v23
  v_and_b32 v27, s45, v27
  v_and_b32 v31, s45, v31
  v_and_b32 v35, s45, v35
  v_and_b32 v39, s45, v39
  v_and_b32 v43, s45, v43
  v_and_b32 v47, s45, v47
  v_add_f32 v23, v23, v27
  v_add_f32 v23, v23, v31
  v_add_f32 v23, v23, v35
  v_add_f32 v23, v23, v39
  v_add_f32 v23, v23, v43
  v_add_f32 v23, v23, v47
  v_lshlrev_b32 v24, 16, v18
  v_and_b32 v25, 0xffff0000, v18
  v_lshlrev_b32 v26, 16, v19
  v_and_b32 v27, 0xffff0000, v19
  v_cvt_pk_bf16_f32 v20, v20, v20
  v_and_b32 v20, 0xffff0000, v20
  v_add_f32 v20, v20, v24
  v_cvt_pk_bf16_f32 v20, v20, v20
  v_and_b32 v20, 0xffff0000, v20
  v_max_f32 v20, 0, v20
  v_mul_f32 v20, v20, v20
  v_cvt_pk_bf16_f32 v20, v20, v20
  v_cvt_pk_bf16_f32 v21, v21, v21
  v_and_b32 v21, 0xffff0000, v21
  v_add_f32 v21, v21, v25
  v_cvt_pk_bf16_f32 v21, v21, v21
  v_and_b32 v21, 0xffff0000, v21
  v_max_f32 v21, 0, v21
  v_mul_f32 v21, v21, v21
  v_cvt_pk_bf16_f32 v21, v21, v21
  v_cvt_pk_bf16_f32 v22, v22, v22
  v_and_b32 v22, 0xffff0000, v22
  v_add_f32 v22, v22, v26
  v_cvt_pk_bf16_f32 v22, v22, v22
  v_and_b32 v22, 0xffff0000, v22
  v_max_f32 v22, 0, v22
  v_mul_f32 v22, v22, v22
  v_cvt_pk_bf16_f32 v22, v22, v22
  v_cvt_pk_bf16_f32 v23, v23, v23
  v_and_b32 v23, 0xffff0000, v23
  v_add_f32 v23, v23, v27
  v_cvt_pk_bf16_f32 v23, v23, v23
  v_and_b32 v23, 0xffff0000, v23
  v_max_f32 v23, 0, v23
  v_mul_f32 v23, v23, v23
  v_cvt_pk_bf16_f32 v23, v23, v23
  v_mul_u32_u24 v16, 144, v13
  v_lshl_add_u32 v16, v14, 4, v16
  s_lshl_b32 s43, s3, 10
  v_add_u32 v16, s43, v16
  ds_write_b128 v16, v[20:23] offset:4096
  s_mov_b64 exec, -1
  s_waitcnt lgkmcnt(0)
L_tdone:
  s_cmp_eq_u32 s38, 1
  s_cbranch_scc1 L_sw2_4
  s_mul_i32 s42, s37, 36864
  s_lshl_b32 s43, s39, 8
  s_add_u32 s42, s42, s43
  s_add_u32 s52, s16, s42
  s_addc_u32 s53, s17, 0
  s_sub_u32 s54, 4718592, s42
  s_mov_b32 s43, 9216
  s_branch L_sd_4
L_sw2_4:
  s_mul_i32 s42, s37, 41472
  s_lshl_b32 s43, s39, 8
  s_add_u32 s42, s42, s43
  s_add_u32 s52, s24, s42
  s_addc_u32 s53, s25, 0
  s_sub_u32 s54, 5308416, s42
  s_mov_b32 s43, 10368
L_sd_4:
  s_and_b32 s53, s53, 0xffff
  s_mov_b32 s55, 0x20000
  s_cmp_eq_u32 s38, 2
  s_cselect_b32 s54, 0, s54
  v_mul_lo_u32 v13, v10, s43
  v_lshl_add_u32 v13, v12, 4, v13
  v_mov_b32 v19, 1073741824
  v_cmp_le_u32 vcc, 8, v12
  s_nop 1
  v_cndmask_b32 v18, v13, v19, vcc
  s_cmp_eq_u32 s39, 4
  s_cbranch_scc0 L_se_4
  v_mov_b32 v13, v18
L_se_4:
  s_cmp_eq_u32 s40, 1
  s_cbranch_scc1 L_sw2_5
  s_mul_i32 s42, s37, 36864
  s_lshl_b32 s43, s41, 8
  s_add_u32 s42, s42, s43
  s_add_u32 s56, s16, s42
  s_addc_u32 s57, s17, 0
  s_sub_u32 s58, 4718592, s42
  s_mov_b32 s43, 9216
  s_branch L_sd_5
L_sw2_5:
  s_mul_i32 s42, s37, 41472
  s_lshl_b32 s43, s41, 8
  s_add_u32 s42, s42, s43
  s_add_u32 s56, s24, s42
  s_addc_u32 s57, s25, 0
  s_sub_u32 s58, 5308416, s42
  s_mov_b32 s43, 10368
L_sd_5:
  s_and_b32 s57, s57, 0xffff
  s_mov_b32 s59, 0x20000
  s_cmp_eq_u32 s40, 2
  s_cselect_b32 s58, 0, s58
  v_mul_lo_u32 v14, v10, s43
  v_lshl_add_u32 v14, v12, 4, v14
  v_mov_b32 v19, 1073741824
  v_cmp_le_u32 vcc, 8, v12
  s_nop 1
  v_cndmask_b32 v18, v14, v19, vcc
  s_cmp_eq_u32 s41, 4
  s_cbranch_scc0 L_se_5
  v_mov_b32 v14, v18
L_se_5:
  v_mov_b32 v19, 1073741824
  s_cmp_eq_u32 s38, 0
  s_cselect_b64 vcc, -1, 0
  v_cndmask_b32 v15, v13, v19, vcc
  s_cmp_eq_u32 s40, 0
  s_cselect_b64 vcc, -1, 0
  v_cndmask_b32 v16, v14, v19, vcc
  v_lshrrev_b32 v90, 3, v0
  v_lshlrev_b32 v90, 14, v90
  v_and_b32 v91, 7, v0
  v_lshl_add_u32 v90, v91, 4, v90
  v_cmp_le_u32 vcc, 32, v0
  s_nop 1
  v_cndmask_b32 v92, v90, v19, vcc
  s_cmp_eq_u32 s41, 4
  s_cselect_b64 vcc, -1, 0
  v_cndmask_b32 v91, v90, v92, vcc
  s_cmp_eq_u32 s39, 4
  s_cselect_b64 vcc, -1, 0
  v_cndmask_b32 v90, v90, v92, vcc
  s_mov_b32 s96, 1048576
  s_cmp_eq_u32 s38, 1
  s_cselect_b32 s96, 2359296, s96
  s_lshl_b32 s42, s39, 17
  s_add_u32 s96, s96, s42
  s_lshl_b32 s42, s37, 7
  s_add_u32 s96, s96, s42
  s_mov_b32 s97, 1048576
  s_cmp_eq_u32 s40, 1
  s_cselect_b32 s97, 2359296, s97
  s_lshl_b32 s42, s41, 17
  s_add_u32 s97, s97, s42
  s_lshl_b32 s42, s37, 7
  s_add_u32 s97, s97, s42
  v_and_b32 v93, 3, v0
  v_bfe_u32 v94, v0, 4, 1
  v_lshl_add_u32 v93, v94, 2, v93
  v_bfe_u32 v94, v0, 2, 2
  v_lshrrev_b32 v95, 5, v0
  v_lshlrev_b32 v96, 12, v95
  v_lshl_add_u32 v96, v94, 9, v96
  v_lshl_add_u32 v96, v93, 4, v96
  v_lshlrev_b32 v97, 7, v95
  v_lshl_add_u32 v97, v94, 4, v97
  s_lshr_b32 s98, s35, 1
  s_lshl_b32 s98, s98, 7
  s_lshl_b32 s42, s34, 13
  s_add_u32 s98, s98, s42
  s_add_u32 s98, s98, 655360
  s_lshl_b32 s99, s34, 8
  s_add_u32 s99, s99, 917504
  s_lshl_b32 s42, s3, 10
  s_add_u32 s42, s42, 4608
  v_lshlrev_b32 v98, 7, v95
  v_lshl_add_u32 v98, v93, 4, v98
  v_add_u32 v98, s42, v98
  v_lshlrev_b32 v99, 7, v11
  v_lshl_add_u32 v99, v10, 5, v99
  v_add_u32 v99, s42, v99
  s_cmp_ge_u32 s3, 2
  s_cbranch_scc0 L_noh2
  v_mul_u32_u24 v20, 144, v11
  v_mad_u32_u24 v20, v10, 36, v20
  s_lshl_b32 s42, s3, 10
  v_add_u32 v20, s42, v20
  ds_read_b32 v100, v20 offset:4096
  ds_read_b32 v101, v20 offset:4100
  ds_read_b32 v102, v20 offset:4104
  ds_read_b32 v103, v20 offset:4108
  ds_read_b32 v104, v20 offset:4112
  ds_read_b32 v105, v20 offset:4116
  ds_read_b32 v106, v20 offset:4120
  ds_read_b32 v107, v20 offset:4124
  ds_read_b32 v108, v20 offset:4128
  s_waitcnt lgkmcnt(0)
L_noh2:
  v_and_b32 v110, 31, v0
  v_lshlrev_b32 v110, 4, v110
  v_lshl_add_u32 v111, v95, 9, v110
  v_lshlrev_b32 v112, 3, v95
  v_lshl_add_u32 v113, v95, 12, v110
  v_lshlrev_b32 v114, 7, v95
  s_lshl_b32 s60, s34, 13
  s_lshl_b32 s43, s35, 9
  s_add_u32 s60, s60, s43
  s_add_u32 s60, s60, 655360
  s_lshl_b32 s61, s34, 8
  s_lshl_b32 s43, s35, 4
  s_add_u32 s61, s61, s43
  s_add_u32 s61, s61, 917504
  s_mov_b32 s62, 0x3fb8aa3b
  s_cmp_eq_u32 s3, 1
  s_cbranch_scc1 L_dry2
  s_cmp_eq_u32 s3, 3
  s_cbranch_scc0 L_nodry2
  s_mov_b32 s100, 1
  s_mov_b32 s101, 1
  s_mov_b32 s50, 0
  s_branch L_comb
L_dry2:
  s_mov_b32 s100, 1
  s_mov_b32 s101, 1
  s_mov_b32 s50, 0
  s_branch L_btX
L_drydone2:
  s_mov_b32 s100, 524288
  s_mov_b32 s101, 0
  s_mov_b32 s50, 5242880
L_nodry2:
  s_mov_b32 s4, 524288
  v_mov_b32 v20, 512
L_poll6:
  ds_read_b32 v21, v20
  s_waitcnt lgkmcnt(0)
  v_readfirstlane_b32 s6, v21
  s_cmp_ge_u32 s6, 4
  s_cbranch_scc1 L_pdone6
  s_sleep 1
  s_sub_u32 s4, s4, 1
  s_cmp_lg_u32 s4, 0
  s_cbranch_scc1 L_poll6
L_pdone6:
  s_mov_b32 s42, 0
  buffer_load_dwordx4 a[0:3], v13, s[52:55], s42 offen nt
  s_add_u32 s42, s42, 1152
  buffer_load_dwordx4 a[4:7], v13, s[52:55], s42 offen nt
  s_add_u32 s42, s42, 1152
  buffer_load_dwordx4 a[8:11], v13, s[52:55], s42 offen nt
  s_add_u32 s42, s42, 1152
  buffer_load_dwordx4 a[12:15], v13, s[52:55], s42 offen nt
  s_add_u32 s42, s42, 1152
  buffer_load_dwordx4 a[16:19], v13, s[52:55], s42 offen nt
  s_add_u32 s42, s42, 1152
  buffer_load_dwordx4 a[20:23], v13, s[52:55], s42 offen nt
  s_add_u32 s42, s42, 1152
  buffer_load_dwordx4 a[24:27], v13, s[52:55], s42 offen nt
  s_add_u32 s42, s42, 1152
  buffer_load_dwordx4 a[28:31], v13, s[52:55], s42 offen nt
  s_add_u32 s42, s42, 1152
  buffer_load_dwordx4 a[32:35], v15, s[52:55], s42 offen nt
  s_cmp_eq_u32 s40, 2
  s_cbranch_scc1 L_noy
  s_mov_b32 s42, 0
  buffer_load_dwordx4 a[36:39], v14, s[56:59], s42 offen nt
  s_add_u32 s42, s42, 1152
  buffer_load_dwordx4 a[40:43], v14, s[56:59], s42 offen nt
  s_add_u32 s42, s42, 1152
  buffer_load_dwordx4 a[44:47], v14, s[56:59], s42 offen nt
  s_add_u32 s42, s42, 1152
  buffer_load_dwordx4 a[48:51], v14, s[56:59], s42 offen nt
  s_add_u32 s42, s42, 1152
  buffer_load_dwordx4 a[52:55], v14, s[56:59], s42 offen nt
  s_add_u32 s42, s42, 1152
  buffer_load_dwordx4 a[56:59], v14, s[56:59], s42 offen nt
  s_add_u32 s42, s42, 1152
  buffer_load_dwordx4 a[60:63], v14, s[56:59], s42 offen nt
  s_add_u32 s42, s42, 1152
  buffer_load_dwordx4 a[64:67], v14, s[56:59], s42 offen nt
  s_add_u32 s42, s42, 1152
  buffer_load_dwordx4 a[68:71], v16, s[56:59], s42 offen nt
L_noy:
  s_cmp_eq_u32 s3, 3
  s_cbranch_scc0 L_nocomb
  s_mov_b32 s4, 524288
  v_mov_b32 v20, 516
L_poll7:
  ds_read_b32 v21, v20
  s_waitcnt lgkmcnt(0)
  v_readfirstlane_b32 s6, v21
  s_cmp_ge_u32 s6, 4
  s_cbranch_scc1 L_pdone7
  s_sub_u32 s4, s4, 1
  s_cmp_lg_u32 s4, 0
  s_cbranch_scc1 L_poll7
L_pdone7:
L_comb:
  ds_read_b64 v[40:41], v112 offset:576
  ds_read_b64 v[42:43], v112 offset:592
  ds_read_b128 v[24:27], v111 offset:1024
  ds_read_b128 v[28:31], v111 offset:2048
  s_waitcnt lgkmcnt(2)
  v_max_f32 v48, v40, v42
  v_sub_f32 v40, v40, v48
  v_sub_f32 v42, v42, v48
  v_mul_f32 v40, s62, v40
  v_mul_f32 v42, s62, v42
  v_exp_f32 v40, v40
  v_exp_f32 v42, v42
  v_mov_b32 v52, 0
  v_mov_b32 v53, 0
  v_mul_f32 v49, v40, v41
  v_fmac_f32 v49, v42, v43
  s_waitcnt lgkmcnt(0)
  v_mul_f32 v44, v40, v24
  v_mul_f32 v45, v40, v25
  v_mul_f32 v46, v40, v26
  v_mul_f32 v47, v40, v27
  v_fmac_f32 v44, v42, v28
  v_fmac_f32 v45, v42, v29
  v_fmac_f32 v46, v42, v30
  v_fmac_f32 v47, v42, v31
  v_bfi_b32 v54, s44, v2, v44
  v_bfi_b32 v55, s44, v3, v45
  v_bfi_b32 v56, s44, v4, v46
  v_bfi_b32 v57, s44, v5, v47
  buffer_store_dwordx4 v[54:57], v113, s[48:51], s60 offen sc1
  v_bfi_b32 v58, s44, v2, v48
  v_bfi_b32 v59, s44, v3, v49
  v_bfi_b32 v60, s44, v4, v52
  v_bfi_b32 v61, s44, v5, v53
  s_mov_b32 exec_lo, 1
  s_mov_b32 exec_hi, 1
  buffer_store_dwordx4 v[58:61], v114, s[48:51], s61 offen sc1
  s_mov_b64 exec, -1
  s_cmp_lg_u32 s101, 0
  s_cbranch_scc1 L_drydone2
L_nocomb:
L_btX:
  s_cmp_eq_u32 s38, 2
  s_cbranch_scc1 L_bt_end8
  s_cmp_eq_u32 s38, 1
  s_cbranch_scc1 L_bt_w28
  s_mov_b32 s4, s100
L_poll9:
  buffer_load_dwordx4 v[24:27], v96, s[48:51], s98 offen sc1
  buffer_load_dwordx4 v[36:39], v96, s[48:51], s98 offen offset:2048 sc1
  buffer_load_dwordx4 v[28:31], v97, s[48:51], s99 offen sc1
  buffer_load_dwordx4 v[40:43], v97, s[48:51], s99 offen offset:64 sc1
  s_waitcnt vmcnt(0)
  v_xor_b32 v32, v24, v2
  v_bitop3_b32 v32, v25, v3, v32 bitop3:0xbe
  v_bitop3_b32 v32, v26, v4, v32 bitop3:0xbe
  v_bitop3_b32 v32, v27, v5, v32 bitop3:0xbe
  v_bitop3_b32 v32, v36, v2, v32 bitop3:0xbe
  v_bitop3_b32 v32, v37, v3, v32 bitop3:0xbe
  v_bitop3_b32 v32, v38, v4, v32 bitop3:0xbe
  v_bitop3_b32 v32, v39, v5, v32 bitop3:0xbe
  v_bitop3_b32 v32, v28, v2, v32 bitop3:0xbe
  v_bitop3_b32 v32, v29, v3, v32 bitop3:0xbe
  v_bitop3_b32 v32, v30, v4, v32 bitop3:0xbe
  v_bitop3_b32 v32, v31, v5, v32 bitop3:0xbe
  v_bitop3_b32 v32, v40, v2, v32 bitop3:0xbe
  v_bitop3_b32 v32, v41, v3, v32 bitop3:0xbe
  v_bitop3_b32 v32, v42, v4, v32 bitop3:0xbe
  v_bitop3_b32 v32, v43, v5, v32 bitop3:0xbe
  v_and_b32 v32, s44, v32
  v_cmp_eq_u32 vcc, 0, v32
  s_cmp_eq_u64 vcc, exec
  s_cbranch_scc1 L_pdone9
  s_sub_u32 s4, s4, 1
  s_cmp_lg_u32 s4, 0
  s_cbranch_scc1 L_poll9
L_pdone9:
  v_max_f32 v30, v28, v40
  s_nop 1
  v_max_f32_dpp v30, v30, v30 row_ror:4 row_mask:0xf bank_mask:0xf
  s_nop 1
  v_max_f32_dpp v30, v30, v30 row_ror:8 row_mask:0xf bank_mask:0xf
  v_sub_f32 v28, v28, v30
  v_sub_f32 v40, v40, v30
  v_mul_f32 v28, s62, v28
  v_mul_f32 v40, s62, v40
  v_exp_f32 v28, v28
  v_exp_f32 v40, v40
  v_mul_f32 v29, v29, v28
  v_mul_f32 v24, v24, v28
  v_mul_f32 v25, v25, v28
  v_mul_f32 v26, v26, v28
  v_mul_f32 v27, v27, v28
  v_fmac_f32 v29, v41, v40
  v_fmac_f32 v24, v36, v40
  v_fmac_f32 v25, v37, v40
  v_fmac_f32 v26, v38, v40
  v_fmac_f32 v27, v39, v40
  v_add_f32_dpp v29, v29, v29 row_ror:4 row_mask:0xf bank_mask:0xf
  v_add_f32_dpp v24, v24, v24 row_ror:4 row_mask:0xf bank_mask:0xf
  v_add_f32_dpp v25, v25, v25 row_ror:4 row_mask:0xf bank_mask:0xf
  v_add_f32_dpp v26, v26, v26 row_ror:4 row_mask:0xf bank_mask:0xf
  v_add_f32_dpp v27, v27, v27 row_ror:4 row_mask:0xf bank_mask:0xf
  v_add_f32_dpp v29, v29, v29 row_ror:8 row_mask:0xf bank_mask:0xf
  v_add_f32_dpp v24, v24, v24 row_ror:8 row_mask:0xf bank_mask:0xf
  v_add_f32_dpp v25, v25, v25 row_ror:8 row_mask:0xf bank_mask:0xf
  v_add_f32_dpp v26, v26, v26 row_ror:8 row_mask:0xf bank_mask:0xf
  v_add_f32_dpp v27, v27, v27 row_ror:8 row_mask:0xf bank_mask:0xf
  v_rcp_f32 v29, v29
  s_nop 0
  v_mul_f32 v24, v24, v29
  v_mul_f32 v25, v25, v29
  v_mul_f32 v26, v26, v29
  v_mul_f32 v27, v27, v29
  v_cvt_pk_bf16_f32 v24, v24, v24
  v_cvt_pk_bf16_f32 v25, v25, v25
  v_cvt_pk_bf16_f32 v26, v26, v26
  v_cvt_pk_bf16_f32 v27, v27, v27
  ds_write_b128 v98, v[24:27]
  s_waitcnt lgkmcnt(0)
  ds_read_b128 v[24:27], v99
  ds_read_b128 v[28:31], v99 offset:16
  s_waitcnt lgkmcnt(0)
  v_and_b32 v76, v24, v6
  v_and_b32 v77, v24, v7
  v_and_b32 v78, v24, v8
  v_and_b32 v79, v24, v9
  v_and_b32 v80, v25, v6
  v_and_b32 v81, v25, v7
  v_and_b32 v82, v25, v8
  v_and_b32 v83, v25, v9
  v_mfma_f32_16x16x32_bf16 v[70:73], a[0:3], v[76:79], 0
  v_and_b32 v76, v26, v6
  v_and_b32 v77, v26, v7
  v_and_b32 v78, v26, v8
  v_and_b32 v79, v26, v9
  v_mfma_f32_16x16x32_bf16 v[70:73], a[4:7], v[80:83], v[70:73]
  v_and_b32 v80, v27, v6
  v_and_b32 v81, v27, v7
  v_and_b32 v82, v27, v8
  v_and_b32 v83, v27, v9
  v_mfma_f32_16x16x32_bf16 v[70:73], a[8:11], v[76:79], v[70:73]
  v_and_b32 v76, v28, v6
  v_and_b32 v77, v28, v7
  v_and_b32 v78, v28, v8
  v_and_b32 v79, v28, v9
  v_mfma_f32_16x16x32_bf16 v[70:73], a[12:15], v[80:83], v[70:73]
  v_and_b32 v80, v29, v6
  v_and_b32 v81, v29, v7
  v_and_b32 v82, v29, v8
  v_and_b32 v83, v29, v9
  v_mfma_f32_16x16x32_bf16 v[70:73], a[16:19], v[76:79], v[70:73]
  v_and_b32 v76, v30, v6
  v_and_b32 v77, v30, v7
  v_and_b32 v78, v30, v8
  v_and_b32 v79, v30, v9
  v_mfma_f32_16x16x32_bf16 v[70:73], a[20:23], v[80:83], v[70:73]
  v_and_b32 v80, v31, v6
  v_and_b32 v81, v31, v7
  v_and_b32 v82, v31, v8
  v_and_b32 v83, v31, v9
  v_mfma_f32_16x16x32_bf16 v[70:73], a[24:27], v[76:79], v[70:73]
  s_nop 0
  v_mfma_f32_16x16x32_bf16 v[70:73], a[28:31], v[80:83], v[70:73]
  s_branch L_bt_pub8
L_bt_w28:
  s_waitcnt vmcnt(0)
  v_and_b32 v76, v100, v6
  v_and_b32 v77, v100, v7
  v_and_b32 v78, v100, v8
  v_and_b32 v79, v100, v9
  v_and_b32 v80, v101, v6
  v_and_b32 v81, v101, v7
  v_and_b32 v82, v101, v8
  v_and_b32 v83, v101, v9
  v_mfma_f32_16x16x32_bf16 v[70:73], a[0:3], v[76:79], 0
  v_and_b32 v76, v102, v6
  v_and_b32 v77, v102, v7
  v_and_b32 v78, v102, v8
  v_and_b32 v79, v102, v9
  v_mfma_f32_16x16x32_bf16 v[70:73], a[4:7], v[80:83], v[70:73]
  v_and_b32 v80, v103, v6
  v_and_b32 v81, v103, v7
  v_and_b32 v82, v103, v8
  v_and_b32 v83, v103, v9
  v_mfma_f32_16x16x32_bf16 v[70:73], a[8:11], v[76:79], v[70:73]
  v_and_b32 v76, v104, v6
  v_and_b32 v77, v104, v7
  v_and_b32 v78, v104, v8
  v_and_b32 v79, v104, v9
  v_mfma_f32_16x16x32_bf16 v[70:73], a[12:15], v[80:83], v[70:73]
  v_and_b32 v80, v105, v6
  v_and_b32 v81, v105, v7
  v_and_b32 v82, v105, v8
  v_and_b32 v83, v105, v9
  v_mfma_f32_16x16x32_bf16 v[70:73], a[16:19], v[76:79], v[70:73]
  v_and_b32 v76, v106, v6
  v_and_b32 v77, v106, v7
  v_and_b32 v78, v106, v8
  v_and_b32 v79, v106, v9
  v_mfma_f32_16x16x32_bf16 v[70:73], a[20:23], v[80:83], v[70:73]
  v_and_b32 v80, v107, v6
  v_and_b32 v81, v107, v7
  v_and_b32 v82, v107, v8
  v_and_b32 v83, v107, v9
  v_mfma_f32_16x16x32_bf16 v[70:73], a[24:27], v[76:79], v[70:73]
  v_and_b32 v76, v108, v6
  v_and_b32 v77, v108, v7
  v_and_b32 v78, v108, v8
  v_and_b32 v79, v108, v9
  v_mfma_f32_16x16x32_bf16 v[70:73], a[28:31], v[80:83], v[70:73]
  s_nop 0
  v_mfma_f32_16x16x32_bf16 v[70:73], a[32:35], v[76:79], v[70:73]
L_bt_pub8:
  s_nop 7
  v_bfi_b32 v74, s44, v2, v70
  v_bfi_b32 v75, s44, v3, v71
  v_bfi_b32 v76, s44, v4, v72
  v_bfi_b32 v77, s44, v5, v73
  buffer_store_dwordx4 v[74:77], v90, s[48:51], s96 offen sc1
L_bt_end8:
  s_cmp_lg_u32 s101, 0
  s_cbranch_scc1 L_drydone2
  s_cmp_eq_u32 s40, 2
  s_cbranch_scc1 L_bt_end10
  s_cmp_eq_u32 s40, 1
  s_cbranch_scc1 L_bt_w210
  s_mov_b32 s4, s100
L_poll11:
  buffer_load_dwordx4 v[24:27], v96, s[48:51], s98 offen sc1
  buffer_load_dwordx4 v[36:39], v96, s[48:51], s98 offen offset:2048 sc1
  buffer_load_dwordx4 v[28:31], v97, s[48:51], s99 offen sc1
  buffer_load_dwordx4 v[40:43], v97, s[48:51], s99 offen offset:64 sc1
  s_waitcnt vmcnt(0)
  v_xor_b32 v32, v24, v2
  v_bitop3_b32 v32, v25, v3, v32 bitop3:0xbe
  v_bitop3_b32 v32, v26, v4, v32 bitop3:0xbe
  v_bitop3_b32 v32, v27, v5, v32 bitop3:0xbe
  v_bitop3_b32 v32, v36, v2, v32 bitop3:0xbe
  v_bitop3_b32 v32, v37, v3, v32 bitop3:0xbe
  v_bitop3_b32 v32, v38, v4, v32 bitop3:0xbe
  v_bitop3_b32 v32, v39, v5, v32 bitop3:0xbe
  v_bitop3_b32 v32, v28, v2, v32 bitop3:0xbe
  v_bitop3_b32 v32, v29, v3, v32 bitop3:0xbe
  v_bitop3_b32 v32, v30, v4, v32 bitop3:0xbe
  v_bitop3_b32 v32, v31, v5, v32 bitop3:0xbe
  v_bitop3_b32 v32, v40, v2, v32 bitop3:0xbe
  v_bitop3_b32 v32, v41, v3, v32 bitop3:0xbe
  v_bitop3_b32 v32, v42, v4, v32 bitop3:0xbe
  v_bitop3_b32 v32, v43, v5, v32 bitop3:0xbe
  v_and_b32 v32, s44, v32
  v_cmp_eq_u32 vcc, 0, v32
  s_cmp_eq_u64 vcc, exec
  s_cbranch_scc1 L_pdone11
  s_sub_u32 s4, s4, 1
  s_cmp_lg_u32 s4, 0
  s_cbranch_scc1 L_poll11
L_pdone11:
  v_max_f32 v30, v28, v40
  s_nop 1
  v_max_f32_dpp v30, v30, v30 row_ror:4 row_mask:0xf bank_mask:0xf
  s_nop 1
  v_max_f32_dpp v30, v30, v30 row_ror:8 row_mask:0xf bank_mask:0xf
  v_sub_f32 v28, v28, v30
  v_sub_f32 v40, v40, v30
  v_mul_f32 v28, s62, v28
  v_mul_f32 v40, s62, v40
  v_exp_f32 v28, v28
  v_exp_f32 v40, v40
  v_mul_f32 v29, v29, v28
  v_mul_f32 v24, v24, v28
  v_mul_f32 v25, v25, v28
  v_mul_f32 v26, v26, v28
  v_mul_f32 v27, v27, v28
  v_fmac_f32 v29, v41, v40
  v_fmac_f32 v24, v36, v40
  v_fmac_f32 v25, v37, v40
  v_fmac_f32 v26, v38, v40
  v_fmac_f32 v27, v39, v40
  v_add_f32_dpp v29, v29, v29 row_ror:4 row_mask:0xf bank_mask:0xf
  v_add_f32_dpp v24, v24, v24 row_ror:4 row_mask:0xf bank_mask:0xf
  v_add_f32_dpp v25, v25, v25 row_ror:4 row_mask:0xf bank_mask:0xf
  v_add_f32_dpp v26, v26, v26 row_ror:4 row_mask:0xf bank_mask:0xf
  v_add_f32_dpp v27, v27, v27 row_ror:4 row_mask:0xf bank_mask:0xf
  v_add_f32_dpp v29, v29, v29 row_ror:8 row_mask:0xf bank_mask:0xf
  v_add_f32_dpp v24, v24, v24 row_ror:8 row_mask:0xf bank_mask:0xf
  v_add_f32_dpp v25, v25, v25 row_ror:8 row_mask:0xf bank_mask:0xf
  v_add_f32_dpp v26, v26, v26 row_ror:8 row_mask:0xf bank_mask:0xf
  v_add_f32_dpp v27, v27, v27 row_ror:8 row_mask:0xf bank_mask:0xf
  v_rcp_f32 v29, v29
  s_nop 0
  v_mul_f32 v24, v24, v29
  v_mul_f32 v25, v25, v29
  v_mul_f32 v26, v26, v29
  v_mul_f32 v27, v27, v29
  v_cvt_pk_bf16_f32 v24, v24, v24
  v_cvt_pk_bf16_f32 v25, v25, v25
  v_cvt_pk_bf16_f32 v26, v26, v26
  v_cvt_pk_bf16_f32 v27, v27, v27
  ds_write_b128 v98, v[24:27]
  s_waitcnt lgkmcnt(0)
  ds_read_b128 v[24:27], v99
  ds_read_b128 v[28:31], v99 offset:16
  s_waitcnt lgkmcnt(0)
  v_and_b32 v76, v24, v6
  v_and_b32 v77, v24, v7
  v_and_b32 v78, v24, v8
  v_and_b32 v79, v24, v9
  v_and_b32 v80, v25, v6
  v_and_b32 v81, v25, v7
  v_and_b32 v82, v25, v8
  v_and_b32 v83, v25, v9
  v_mfma_f32_16x16x32_bf16 v[70:73], a[36:39], v[76:79], 0
  v_and_b32 v76, v26, v6
  v_and_b32 v77, v26, v7
  v_and_b32 v78, v26, v8
  v_and_b32 v79, v26, v9
  v_mfma_f32_16x16x32_bf16 v[70:73], a[40:43], v[80:83], v[70:73]
  v_and_b32 v80, v27, v6
  v_and_b32 v81, v27, v7
  v_and_b32 v82, v27, v8
  v_and_b32 v83, v27, v9
  v_mfma_f32_16x16x32_bf16 v[70:73], a[44:47], v[76:79], v[70:73]
  v_and_b32 v76, v28, v6
  v_and_b32 v77, v28, v7
  v_and_b32 v78, v28, v8
  v_and_b32 v79, v28, v9
  v_mfma_f32_16x16x32_bf16 v[70:73], a[48:51], v[80:83], v[70:73]
  v_and_b32 v80, v29, v6
  v_and_b32 v81, v29, v7
  v_and_b32 v82, v29, v8
  v_and_b32 v83, v29, v9
  v_mfma_f32_16x16x32_bf16 v[70:73], a[52:55], v[76:79], v[70:73]
  v_and_b32 v76, v30, v6
  v_and_b32 v77, v30, v7
  v_and_b32 v78, v30, v8
  v_and_b32 v79, v30, v9
  v_mfma_f32_16x16x32_bf16 v[70:73], a[56:59], v[80:83], v[70:73]
  v_and_b32 v80, v31, v6
  v_and_b32 v81, v31, v7
  v_and_b32 v82, v31, v8
  v_and_b32 v83, v31, v9
  v_mfma_f32_16x16x32_bf16 v[70:73], a[60:63], v[76:79], v[70:73]
  s_nop 0
  v_mfma_f32_16x16x32_bf16 v[70:73], a[64:67], v[80:83], v[70:73]
  s_branch L_bt_pub10
L_bt_w210:
  s_waitcnt vmcnt(0)
  v_and_b32 v76, v100, v6
  v_and_b32 v77, v100, v7
  v_and_b32 v78, v100, v8
  v_and_b32 v79, v100, v9
  v_and_b32 v80, v101, v6
  v_and_b32 v81, v101, v7
  v_and_b32 v82, v101, v8
  v_and_b32 v83, v101, v9
  v_mfma_f32_16x16x32_bf16 v[70:73], a[36:39], v[76:79], 0
  v_and_b32 v76, v102, v6
  v_and_b32 v77, v102, v7
  v_and_b32 v78, v102, v8
  v_and_b32 v79, v102, v9
  v_mfma_f32_16x16x32_bf16 v[70:73], a[40:43], v[80:83], v[70:73]
  v_and_b32 v80, v103, v6
  v_and_b32 v81, v103, v7
  v_and_b32 v82, v103, v8
  v_and_b32 v83, v103, v9
  v_mfma_f32_16x16x32_bf16 v[70:73], a[44:47], v[76:79], v[70:73]
  v_and_b32 v76, v104, v6
  v_and_b32 v77, v104, v7
  v_and_b32 v78, v104, v8
  v_and_b32 v79, v104, v9
  v_mfma_f32_16x16x32_bf16 v[70:73], a[48:51], v[80:83], v[70:73]
  v_and_b32 v80, v105, v6
  v_and_b32 v81, v105, v7
  v_and_b32 v82, v105, v8
  v_and_b32 v83, v105, v9
  v_mfma_f32_16x16x32_bf16 v[70:73], a[52:55], v[76:79], v[70:73]
  v_and_b32 v76, v106, v6
  v_and_b32 v77, v106, v7
  v_and_b32 v78, v106, v8
  v_and_b32 v79, v106, v9
  v_mfma_f32_16x16x32_bf16 v[70:73], a[56:59], v[80:83], v[70:73]
  v_and_b32 v80, v107, v6
  v_and_b32 v81, v107, v7
  v_and_b32 v82, v107, v8
  v_and_b32 v83, v107, v9
  v_mfma_f32_16x16x32_bf16 v[70:73], a[60:63], v[76:79], v[70:73]
  v_and_b32 v76, v108, v6
  v_and_b32 v77, v108, v7
  v_and_b32 v78, v108, v8
  v_and_b32 v79, v108, v9
  v_mfma_f32_16x16x32_bf16 v[70:73], a[64:67], v[80:83], v[70:73]
  s_nop 0
  v_mfma_f32_16x16x32_bf16 v[70:73], a[68:71], v[76:79], v[70:73]
L_bt_pub10:
  s_nop 7
  v_bfi_b32 v74, s44, v2, v70
  v_bfi_b32 v75, s44, v3, v71
  v_bfi_b32 v76, s44, v4, v72
  v_bfi_b32 v77, s44, v5, v73
  buffer_store_dwordx4 v[74:77], v91, s[48:51], s97 offen sc1
L_bt_end10:
  s_cmp_ge_u32 s2, 36
  s_cbranch_scc1 L_auxend
L_red:
  s_lshr_b32 s36, s2, 3
  s_and_b32 s37, s2, 7
  s_lshl_b32 s38, s36, 7
  s_lshr_b32 s39, s37, 1
  s_lshl_b32 s39, s39, 5
  s_add_u32 s38, s38, s39
  s_and_b32 s39, s37, 1
  s_mul_i32 s39, s39, 576
  s_add_u32 s39, s39, s38
  s_mov_b32 s60, s8
  s_and_b32 s61, s9, 0xffff
  s_mov_b32 s62, 2304
  s_mov_b32 s63, 0x20000
  s_mov_b32 s56, s26
  s_and_b32 s57, s27, 0xffff
  s_mov_b32 s58, 1152
  s_mov_b32 s59, 0x20000
  v_lshlrev_b32 v13, 1, v0
  s_lshl_b32 s40, s39, 1
  s_lshl_b32 s41, s38, 1
  v_and_b32 v16, 3, v0
  v_bfe_u32 v17, v0, 4, 1
  v_lshl_add_u32 v16, v17, 2, v16
  v_bfe_u32 v17, v0, 2, 2
  v_lshrrev_b32 v18, 5, v0
  v_lshl_add_u32 v17, v18, 2, v17
  v_lshlrev_b32 v19, 4, v16
  v_lshl_add_u32 v16, v17, 7, v19
  v_lshl_add_u32 v17, v18, 7, v19
  s_lshl_b32 s43, s3, 8
  v_add_u32 v17, s43, v17
  s_lshl_b32 s42, s2, 14
  s_lshl_b32 s43, s3, 12
  s_add_u32 s42, s42, s43
  s_add_u32 s43, s42, 1048576
  s_add_u32 s42, s42, 2359296
  s_mov_b32 exec_lo, -1
  s_mov_b32 exec_hi, 0
  buffer_load_ushort v14, v13, s[60:63], s40 offen
  buffer_load_ushort v15, v13, s[56:59], s41 offen
  s_mov_b64 exec, -1
  s_mov_b32 s60, s28
  s_and_b32 s61, s29, 0xffff
  s_mov_b32 s4, s100
L_poll12:
  buffer_load_dwordx4 v[20:23], v16, s[48:51], s42 offen offset:0 sc1
  buffer_load_dwordx4 v[24:27], v16, s[48:51], s42 offen offset:1024 sc1
  buffer_load_dwordx4 v[28:31], v16, s[48:51], s42 offen offset:2048 sc1
  buffer_load_dwordx4 v[32:35], v16, s[48:51], s42 offen offset:3072 sc1
  buffer_load_dwordx4 v[36:39], v16, s[48:51], s43 offen offset:0 sc1
  buffer_load_dwordx4 v[40:43], v16, s[48:51], s43 offen offset:1024 sc1
  buffer_load_dwordx4 v[44:47], v16, s[48:51], s43 offen offset:2048 sc1
  buffer_load_dwordx4 v[48:51], v16, s[48:51], s43 offen offset:3072 sc1
  s_waitcnt vmcnt(0)
  v_xor_b32 v52, v20, v2
  v_bitop3_b32 v52, v21, v3, v52 bitop3:0xbe
  v_bitop3_b32 v52, v22, v4, v52 bitop3:0xbe
  v_bitop3_b32 v52, v23, v5, v52 bitop3:0xbe
  v_bitop3_b32 v52, v24, v2, v52 bitop3:0xbe
  v_bitop3_b32 v52, v25, v3, v52 bitop3:0xbe
  v_bitop3_b32 v52, v26, v4, v52 bitop3:0xbe
  v_bitop3_b32 v52, v27, v5, v52 bitop3:0xbe
  v_bitop3_b32 v52, v28, v2, v52 bitop3:0xbe
  v_bitop3_b32 v52, v29, v3, v52 bitop3:0xbe
  v_bitop3_b32 v52, v30, v4, v52 bitop3:0xbe
  v_bitop3_b32 v52, v31, v5, v52 bitop3:0xbe
  v_bitop3_b32 v52, v32, v2, v52 bitop3:0xbe
  v_bitop3_b32 v52, v33, v3, v52 bitop3:0xbe
  v_bitop3_b32 v52, v34, v4, v52 bitop3:0xbe
  v_bitop3_b32 v52, v35, v5, v52 bitop3:0xbe
  v_bitop3_b32 v52, v36, v2, v52 bitop3:0xbe
  v_bitop3_b32 v52, v37, v3, v52 bitop3:0xbe
  v_bitop3_b32 v52, v38, v4, v52 bitop3:0xbe
  v_bitop3_b32 v52, v39, v5, v52 bitop3:0xbe
  v_bitop3_b32 v52, v40, v2, v52 bitop3:0xbe
  v_bitop3_b32 v52, v41, v3, v52 bitop3:0xbe
  v_bitop3_b32 v52, v42, v4, v52 bitop3:0xbe
  v_bitop3_b32 v52, v43, v5, v52 bitop3:0xbe
  v_bitop3_b32 v52, v44, v2, v52 bitop3:0xbe
  v_bitop3_b32 v52, v45, v3, v52 bitop3:0xbe
  v_bitop3_b32 v52, v46, v4, v52 bitop3:0xbe
  v_bitop3_b32 v52, v47, v5, v52 bitop3:0xbe
  v_bitop3_b32 v52, v48, v2, v52 bitop3:0xbe
  v_bitop3_b32 v52, v49, v3, v52 bitop3:0xbe
  v_bitop3_b32 v52, v50, v4, v52 bitop3:0xbe
  v_bitop3_b32 v52, v51, v5, v52 bitop3:0xbe
  v_and_b32 v52, s44, v52
  v_cmp_eq_u32 vcc, 0, v52
  s_cmp_eq_u64 vcc, exec
  s_cbranch_scc1 L_pdone12
  s_sub_u32 s4, s4, 1
  s_cmp_lg_u32 s4, 0
  s_cbranch_scc1 L_poll12
L_pdone12:
  v_add_f32 v20, v20, v24
  v_add_f32 v21, v21, v25
  v_add_f32 v22, v22, v26
  v_add_f32 v23, v23, v27
  v_add_f32 v28, v28, v32
  v_add_f32 v29, v29, v33
  v_add_f32 v30, v30, v34
  v_add_f32 v31, v31, v35
  v_add_f32 v20, v20, v28
  v_add_f32 v21, v21, v29
  v_add_f32 v22, v22, v30
  v_add_f32 v23, v23, v31
  v_add_f32 v36, v36, v40
  v_add_f32 v37, v37, v41
  v_add_f32 v38, v38, v42
  v_add_f32 v39, v39, v43
  v_add_f32 v44, v44, v48
  v_add_f32 v45, v45, v49
  v_add_f32 v46, v46, v50
  v_add_f32 v47, v47, v51
  v_add_f32 v36, v36, v44
  v_add_f32 v37, v37, v45
  v_add_f32 v38, v38, v46
  v_add_f32 v39, v39, v47
  v_add_f32_dpp v20, v20, v20 row_ror:4 row_mask:0xf bank_mask:0xf
  v_add_f32_dpp v21, v21, v21 row_ror:4 row_mask:0xf bank_mask:0xf
  v_add_f32_dpp v22, v22, v22 row_ror:4 row_mask:0xf bank_mask:0xf
  v_add_f32_dpp v23, v23, v23 row_ror:4 row_mask:0xf bank_mask:0xf
  v_add_f32_dpp v36, v36, v36 row_ror:4 row_mask:0xf bank_mask:0xf
  v_add_f32_dpp v37, v37, v37 row_ror:4 row_mask:0xf bank_mask:0xf
  v_add_f32_dpp v38, v38, v38 row_ror:4 row_mask:0xf bank_mask:0xf
  v_add_f32_dpp v39, v39, v39 row_ror:4 row_mask:0xf bank_mask:0xf
  v_add_f32_dpp v20, v20, v20 row_ror:8 row_mask:0xf bank_mask:0xf
  v_add_f32_dpp v21, v21, v21 row_ror:8 row_mask:0xf bank_mask:0xf
  v_add_f32_dpp v22, v22, v22 row_ror:8 row_mask:0xf bank_mask:0xf
  v_add_f32_dpp v23, v23, v23 row_ror:8 row_mask:0xf bank_mask:0xf
  v_add_f32_dpp v36, v36, v36 row_ror:8 row_mask:0xf bank_mask:0xf
  v_add_f32_dpp v37, v37, v37 row_ror:8 row_mask:0xf bank_mask:0xf
  v_add_f32_dpp v38, v38, v38 row_ror:8 row_mask:0xf bank_mask:0xf
  v_add_f32_dpp v39, v39, v39 row_ror:8 row_mask:0xf bank_mask:0xf
  ds_write_b128 v17, v[20:23] offset:8192
  ds_write_b128 v17, v[36:39] offset:9216
  v_and_b32 v17, 7, v0
  v_lshlrev_b32 v17, 4, v17
  v_bfe_u32 v18, v0, 3, 2
  v_lshl_add_u32 v17, v18, 2, v17
  s_waitcnt lgkmcnt(0)
  s_cmp_lg_u32 s101, 0
  s_cbranch_scc1 L_redfin
  s_barrier
  s_cmp_eq_u32 s3, 0
  s_cbranch_scc0 L_auxend
L_redfin:
  ds_read_b32 v20, v17 offset:8192
  ds_read_b32 v21, v17 offset:8320
  ds_read_b32 v22, v17 offset:8448
  ds_read_b32 v23, v17 offset:8576
  ds_read_b32 v24, v17 offset:8704
  ds_read_b32 v25, v17 offset:8832
  ds_read_b32 v26, v17 offset:8960
  ds_read_b32 v27, v17 offset:9088
  ds_read_b32 v28, v17 offset:9216
  ds_read_b32 v29, v17 offset:9344
  ds_read_b32 v30, v17 offset:9472
  ds_read_b32 v31, v17 offset:9600
  ds_read_b32 v32, v17 offset:9728
  ds_read_b32 v33, v17 offset:9856
  ds_read_b32 v34, v17 offset:9984
  ds_read_b32 v35, v17 offset:10112
  v_lshlrev_b32 v14, 16, v14
  v_lshlrev_b32 v15, 16, v15
  s_waitcnt lgkmcnt(8)
  v_add_f32 v20, v20, v21
  v_add_f32 v22, v22, v23
  v_add_f32 v24, v24, v25
  v_add_f32 v26, v26, v27
  v_add_f32 v20, v20, v22
  v_add_f32 v24, v24, v26
  v_add_f32 v20, v20, v24
  v_cvt_pk_bf16_f32 v20, v20, v20
  v_and_b32 v20, 0xffff0000, v20
  v_add_f32 v20, v20, v15
  v_cvt_pk_bf16_f32 v20, v20, v20
  v_and_b32 v20, 0xffff0000, v20
  v_mul_f32 v21, 0xbfb8aa3b, v20
  v_exp_f32 v21, v21
  s_waitcnt lgkmcnt(0)
  v_add_f32 v28, v28, v29
  v_add_f32 v30, v30, v31
  v_add_f32 v32, v32, v33
  v_add_f32 v34, v34, v35
  v_add_f32 v28, v28, v30
  v_add_f32 v32, v32, v34
  v_add_f32 v28, v28, v32
  v_add_f32 v21, 1.0, v21
  v_rcp_f32 v21, v21
  v_cvt_pk_bf16_f32 v28, v28, v28
  v_and_b32 v28, 0xffff0000, v28
  v_mul_f32 v20, v20, v21
  v_cvt_pk_bf16_f32 v20, v20, v20
  v_and_b32 v20, 0xffff0000, v20
  v_mul_f32 v20, v28, v20
  v_cvt_pk_bf16_f32 v20, v20, v20
  v_and_b32 v20, 0xffff0000, v20
  v_add_f32 v20, v14, v20
  v_cvt_pk_bf16_f32 v20, v20, v20
  s_cmp_lg_u32 s101, 0
  s_cselect_b32 s62, 0, s62
  s_mov_b32 exec_lo, -1
  s_mov_b32 exec_hi, 0
  buffer_store_short v20, v13, s[60:63], s40 offen
  s_mov_b64 exec, -1
  s_cmp_lg_u32 s101, 0
  s_cbranch_scc1 L_drydone1
  s_cmp_eq_u32 s2, 0
  s_cbranch_scc0 L_auxend
  s_mov_b64 exec, 1
  v_mov_b32 v20, s46
  v_mov_b32 v21, s47
  v_mov_b32 v22, 0
  buffer_store_dwordx2 v[20:21], v22, s[48:51], 0 offen sc1
  s_mov_b64 exec, -1
L_auxend:
L_end:
  s_endpgm
L_stream:
  s_sub_u32 s3, s3, 4
  s_and_b32 s37, s3, 1
  s_lshl_b32 s36, s37, 5
  s_add_u32 s36, s36, s34
  s_lshl_b32 s36, s36, 20
  s_waitcnt lgkmcnt(0)
  s_add_u32 s48, s10, s36
  s_addc_u32 s49, s11, 0
  s_and_b32 s49, s49, 0xffff
  s_mov_b32 s50, 0x100000
  s_mov_b32 s51, 0x20000
  s_add_u32 s52, s12, s36
  s_addc_u32 s53, s13, 0
  s_and_b32 s53, s53, 0xffff
  s_mov_b32 s54, 0x100000
  s_mov_b32 s55, 0x20000
  s_lshr_b32 s39, s3, 1
  s_lshl_b32 s80, s35, 1
  s_add_u32 s80, s80, s39
  v_lshlrev_b32 v1, 4, v0
  s_barrier
  s_lshr_b32 s84, s80, 4
  s_lshl_b32 s84, s84, 1
  s_add_u32 s84, s84, s80
  s_and_b32 s84, s84, 15
  s_andn2_b32 s85, s80, 15
  s_or_b32 s84, s84, s85
  s_lshl_b32 s38, s84, 12
  s_add_u32 s80, s80, 16
  buffer_load_dwordx4 v[40:43], v1, s[48:51], s38 offen offset:0 nt
  buffer_load_dwordx4 v[44:47], v1, s[48:51], s38 offen offset:1024 nt
  buffer_load_dwordx4 v[48:51], v1, s[48:51], s38 offen offset:2048 nt
  buffer_load_dwordx4 v[52:55], v1, s[48:51], s38 offen offset:3072 nt
  buffer_load_dwordx4 a[0:3], v1, s[52:55], s38 offen offset:0 nt
  buffer_load_dwordx4 a[4:7], v1, s[52:55], s38 offen offset:1024 nt
  buffer_load_dwordx4 a[8:11], v1, s[52:55], s38 offen offset:2048 nt
  buffer_load_dwordx4 a[12:15], v1, s[52:55], s38 offen offset:3072 nt
  s_lshr_b32 s84, s80, 4
  s_lshl_b32 s84, s84, 1
  s_add_u32 s84, s84, s80
  s_and_b32 s84, s84, 15
  s_andn2_b32 s85, s80, 15
  s_or_b32 s84, s84, s85
  s_lshl_b32 s38, s84, 12
  s_add_u32 s80, s80, 16
  buffer_load_dwordx4 v[56:59], v1, s[48:51], s38 offen offset:0 nt
  buffer_load_dwordx4 v[60:63], v1, s[48:51], s38 offen offset:1024 nt
  buffer_load_dwordx4 v[64:67], v1, s[48:51], s38 offen offset:2048 nt
  buffer_load_dwordx4 v[68:71], v1, s[48:51], s38 offen offset:3072 nt
  buffer_load_dwordx4 a[16:19], v1, s[52:55], s38 offen offset:0 nt
  buffer_load_dwordx4 a[20:23], v1, s[52:55], s38 offen offset:1024 nt
  buffer_load_dwordx4 a[24:27], v1, s[52:55], s38 offen offset:2048 nt
  buffer_load_dwordx4 a[28:31], v1, s[52:55], s38 offen offset:3072 nt
  s_lshr_b32 s84, s80, 4
  s_lshl_b32 s84, s84, 1
  s_add_u32 s84, s84, s80
  s_and_b32 s84, s84, 15
  s_andn2_b32 s85, s80, 15
  s_or_b32 s84, s84, s85
  s_lshl_b32 s38, s84, 12
  s_add_u32 s80, s80, 16
  s_waitcnt vmcnt(12)
  buffer_load_dwordx4 v[72:75], v1, s[48:51], s38 offen offset:0 nt
  buffer_load_dwordx4 v[76:79], v1, s[48:51], s38 offen offset:1024 nt
  buffer_load_dwordx4 v[80:83], v1, s[48:51], s38 offen offset:2048 nt
  buffer_load_dwordx4 v[84:87], v1, s[48:51], s38 offen offset:3072 nt
  s_waitcnt vmcnt(12)
  buffer_load_dwordx4 a[32:35], v1, s[52:55], s38 offen offset:0 nt
  buffer_load_dwordx4 a[36:39], v1, s[52:55], s38 offen offset:1024 nt
  buffer_load_dwordx4 a[40:43], v1, s[52:55], s38 offen offset:2048 nt
  buffer_load_dwordx4 a[44:47], v1, s[52:55], s38 offen offset:3072 nt
  s_lshr_b32 s84, s80, 4
  s_lshl_b32 s84, s84, 1
  s_add_u32 s84, s84, s80
  s_and_b32 s84, s84, 15
  s_andn2_b32 s85, s80, 15
  s_or_b32 s84, s84, s85
  s_lshl_b32 s38, s84, 12
  s_add_u32 s80, s80, 16
  s_waitcnt vmcnt(12)
  buffer_load_dwordx4 v[88:91], v1, s[48:51], s38 offen offset:0 nt
  buffer_load_dwordx4 v[92:95], v1, s[48:51], s38 offen offset:1024 nt
  buffer_load_dwordx4 v[96:99], v1, s[48:51], s38 offen offset:2048 nt
  buffer_load_dwordx4 v[100:103], v1, s[48:51], s38 offen offset:3072 nt
  s_waitcnt vmcnt(12)
  buffer_load_dwordx4 a[48:51], v1, s[52:55], s38 offen offset:0 nt
  buffer_load_dwordx4 a[52:55], v1, s[52:55], s38 offen offset:1024 nt
  buffer_load_dwordx4 a[56:59], v1, s[52:55], s38 offen offset:2048 nt
  buffer_load_dwordx4 a[60:63], v1, s[52:55], s38 offen offset:3072 nt
  s_lshr_b32 s84, s80, 4
  s_lshl_b32 s84, s84, 1
  s_add_u32 s84, s84, s80
  s_and_b32 s84, s84, 15
  s_andn2_b32 s85, s80, 15
  s_or_b32 s84, s84, s85
  s_lshl_b32 s38, s84, 12
  s_add_u32 s80, s80, 16
  s_waitcnt vmcnt(12)
  buffer_load_dwordx4 v[104:107], v1, s[48:51], s38 offen offset:0 nt
  buffer_load_dwordx4 v[108:111], v1, s[48:51], s38 offen offset:1024 nt
  buffer_load_dwordx4 v[112:115], v1, s[48:51], s38 offen offset:2048 nt
  buffer_load_dwordx4 v[116:119], v1, s[48:51], s38 offen offset:3072 nt
  s_waitcnt vmcnt(12)
  buffer_load_dwordx4 a[64:67], v1, s[52:55], s38 offen offset:0 nt
  buffer_load_dwordx4 a[68:71], v1, s[52:55], s38 offen offset:1024 nt
  buffer_load_dwordx4 a[72:75], v1, s[52:55], s38 offen offset:2048 nt
  buffer_load_dwordx4 a[76:79], v1, s[52:55], s38 offen offset:3072 nt
  s_lshr_b32 s84, s80, 4
  s_lshl_b32 s84, s84, 1
  s_add_u32 s84, s84, s80
  s_and_b32 s84, s84, 15
  s_andn2_b32 s85, s80, 15
  s_or_b32 s84, s84, s85
  s_lshl_b32 s38, s84, 12
  s_add_u32 s80, s80, 16
  s_waitcnt vmcnt(12)
  buffer_load_dwordx4 v[120:123], v1, s[48:51], s38 offen offset:0 nt
  buffer_load_dwordx4 v[124:127], v1, s[48:51], s38 offen offset:1024 nt
  buffer_load_dwordx4 v[128:131], v1, s[48:51], s38 offen offset:2048 nt
  buffer_load_dwordx4 v[132:135], v1, s[48:51], s38 offen offset:3072 nt
  s_waitcnt vmcnt(12)
  buffer_load_dwordx4 a[80:83], v1, s[52:55], s38 offen offset:0 nt
  buffer_load_dwordx4 a[84:87], v1, s[52:55], s38 offen offset:1024 nt
  buffer_load_dwordx4 a[88:91], v1, s[52:55], s38 offen offset:2048 nt
  buffer_load_dwordx4 a[92:95], v1, s[52:55], s38 offen offset:3072 nt
  v_and_b32 v20, 1, v0
  v_lshlrev_b32 v20, 4, v20
  v_mov_b32 v21, 0xffff
  v_lshlrev_b32 v20, v20, v21
  v_bfe_u32 v21, v0, 1, 2
  v_cmp_eq_u32 vcc, 0, v21
  s_nop 1
  v_cndmask_b32 v6, 0, v20, vcc
  v_cmp_eq_u32 vcc, 1, v21
  s_nop 1
  v_cndmask_b32 v7, 0, v20, vcc
  v_cmp_eq_u32 vcc, 2, v21
  s_nop 1
  v_cndmask_b32 v8, 0, v20, vcc
  v_cmp_eq_u32 vcc, 3, v21
  s_nop 1
  v_cndmask_b32 v9, 0, v20, vcc
  s_mov_b32 s81, 2
  s_mov_b32 s82, 0
  s_mov_b32 s83, 8
  s_mov_b32 s62, 0
  s_mov_b32 s56, 0
  s_mov_b32 s57, 0
  s_mov_b32 s58, 0
  s_mov_b32 s59, 0
  s_mov_b32 s60, 0
  s_mov_b32 s61, 0
  s_mov_b32 s42, 0xf0f0f0f0
  s_mov_b32 s43, 0xf0f0f0f0
  v_mov_b32 v35, 0xff800000
  v_mov_b32 v10, 0
  v_mov_b32 v11, 0
  v_mov_b32 v12, 0
  v_mov_b32 v13, 0
  v_mov_b32 v14, 0xff800000
  v_mov_b32 v15, 0
  v_and_b32 v16, 15, v0
  v_lshlrev_b32 v16, 4, v16
  s_lshl_b32 s40, s37, 8
  v_add_u32 v16, s40, v16
  s_mov_b32 s86, 0
  s_mov_b32 s88, 0x400000
  s_mov_b32 s40, 0x3db504f3
  s_mov_b32 s41, 0x3fb8aa3b
  v_mov_b32 v36, 520
  v_mov_b32 v20, 524
L_qspin:
  ds_read_b32 v21, v20
  s_waitcnt lgkmcnt(0)
  v_readfirstlane_b32 s90, v21
  s_cmp_lg_u32 s90, 0
  s_cbranch_scc1 L_qgo
  s_sleep 1
  s_sub_u32 s88, s88, 1
  s_cmp_lg_u32 s88, 0
  s_cbranch_scc1 L_qspin
L_qgo:
  ds_read_b128 v[2:5], v16 offset:0
  s_waitcnt lgkmcnt(0)
L_sloop:
  s_cmp_eq_u32 s86, 0
  s_cbranch_scc1 L_nw0
  s_cmp_eq_u32 s89, 0
  s_cbranch_scc1 L_sdone
  s_sub_u32 s89, s89, 1
  s_cmp_ge_u32 s89, 2
  s_cbranch_scc1 L_dw0
  s_cmp_eq_u32 s89, 1
  s_cbranch_scc1 L_w80
  s_waitcnt vmcnt(0)
  s_branch L_go0
L_w80:
  s_waitcnt vmcnt(8)
  s_branch L_go0
L_dw0:
  s_waitcnt vmcnt(16)
  s_branch L_go0
L_nw0:
  s_waitcnt vmcnt(40)
L_go0:
  v_dot2_f32_bf16 v16, v40, v2, 0
  v_dot2_f32_bf16 v17, v44, v2, 0
  v_dot2_f32_bf16 v18, v48, v2, 0
  v_dot2_f32_bf16 v19, v52, v2, 0
  v_dot2c_f32_bf16 v16, v41, v3
  v_dot2c_f32_bf16 v17, v45, v3
  v_dot2c_f32_bf16 v18, v49, v3
  v_dot2c_f32_bf16 v19, v53, v3
  v_dot2c_f32_bf16 v16, v42, v4
  v_dot2c_f32_bf16 v17, v46, v4
  v_dot2c_f32_bf16 v18, v50, v4
  v_dot2c_f32_bf16 v19, v54, v4
  v_dot2c_f32_bf16 v16, v43, v5
  v_dot2c_f32_bf16 v17, v47, v5
  v_dot2c_f32_bf16 v18, v51, v5
  v_dot2c_f32_bf16 v19, v55, v5
  v_add_f32_dpp v20, v16, v16 row_ror:8 row_mask:0xf bank_mask:0x3
  s_nop 0
  v_add_f32_dpp v21, v18, v18 row_ror:8 row_mask:0xf bank_mask:0x3
  v_add_f32_dpp v20, v17, v17 row_ror:8 row_mask:0xf bank_mask:0xc
  s_nop 0
  v_add_f32_dpp v21, v19, v19 row_ror:8 row_mask:0xf bank_mask:0xc
  v_add_f32_dpp v22, v20, v20 row_shl:4 row_mask:0xf bank_mask:0x5
  s_nop 1
  v_add_f32_dpp v22, v21, v21 row_shr:4 row_mask:0xf bank_mask:0xa
  s_nop 1
  v_add_f32_dpp v22, v22, v22 quad_perm:[1,0,3,2] row_mask:0xf bank_mask:0xf
  s_nop 1
  v_add_f32_dpp v22, v22, v22 quad_perm:[2,3,0,1] row_mask:0xf bank_mask:0xf
  v_cvt_pk_bf16_f32 v23, v22, v22
  v_and_b32 v23, 0xffff0000, v23
  v_mul_f32 v23, s40, v23
  v_cvt_pk_bf16_f32 v23, v23, v23
  v_and_b32 v23, 0xffff0000, v23
  s_cmp_eq_u32 s56, 0
  s_cbranch_scc1 L_nh0
  v_cndmask_b32 v23, v23, v35, s[42:43]
L_nh0:
  v_cmp_lt_f32 vcc, v14, v23
  s_cmp_lg_u64 vcc, 0
  s_cbranch_scc0 L_nomax0
  v_max_f32_dpp v24, v23, v23 row_ror:4 row_mask:0xf bank_mask:0xf
  s_nop 1
  v_max_f32_dpp v24, v24, v24 row_ror:8 row_mask:0xf bank_mask:0xf
  v_mov_b32 v25, v24
  s_nop 1
  v_permlane16_swap_b32 v24, v25
  v_max_f32 v24, v24, v25
  v_mov_b32 v25, v24
  s_nop 1
  v_permlane32_swap_b32 v24, v25
  v_max3_f32 v24, v24, v25, v14
  v_sub_f32 v25, v14, v24
  v_mul_f32 v25, s41, v25
  v_exp_f32 v25, v25
  v_mov_b32 v14, v24
  v_mul_f32 v15, v15, v25
  v_mul_f32 v10, v10, v25
  v_mul_f32 v11, v11, v25
  v_mul_f32 v12, v12, v25
  v_mul_f32 v13, v13, v25
L_nomax0:
  v_sub_f32 v26, v23, v14
  v_mul_f32 v26, s41, v26
  v_exp_f32 v26, v26
  s_nop 0
  v_cvt_pk_bf16_f32 v27, v26, v26
  v_add_f32 v15, v15, v26
  s_nop 0
  v_and_b32_dpp v28, v27, v6 row_newbcast:0 row_mask:0xf bank_mask:0xf
  v_and_b32_dpp v29, v27, v7 row_newbcast:0 row_mask:0xf bank_mask:0xf
  v_and_b32_dpp v30, v27, v8 row_newbcast:0 row_mask:0xf bank_mask:0xf
  v_and_b32_dpp v31, v27, v9 row_newbcast:0 row_mask:0xf bank_mask:0xf
  v_and_b32_dpp v16, v27, v6 row_newbcast:8 row_mask:0xf bank_mask:0xf
  v_and_b32_dpp v17, v27, v7 row_newbcast:8 row_mask:0xf bank_mask:0xf
  v_and_b32_dpp v18, v27, v8 row_newbcast:8 row_mask:0xf bank_mask:0xf
  v_and_b32_dpp v19, v27, v9 row_newbcast:8 row_mask:0xf bank_mask:0xf
  v_mfma_f32_16x16x32_bf16 v[10:13], a[0:3], v[28:31], v[10:13]
  v_and_b32_dpp v28, v27, v6 row_newbcast:4 row_mask:0xf bank_mask:0xf
  v_and_b32_dpp v29, v27, v7 row_newbcast:4 row_mask:0xf bank_mask:0xf
  v_and_b32_dpp v30, v27, v8 row_newbcast:4 row_mask:0xf bank_mask:0xf
  v_and_b32_dpp v31, v27, v9 row_newbcast:4 row_mask:0xf bank_mask:0xf
  v_mfma_f32_16x16x32_bf16 v[10:13], a[4:7], v[16:19], v[10:13]
  v_and_b32_dpp v16, v27, v6 row_newbcast:12 row_mask:0xf bank_mask:0xf
  v_and_b32_dpp v17, v27, v7 row_newbcast:12 row_mask:0xf bank_mask:0xf
  v_and_b32_dpp v18, v27, v8 row_newbcast:12 row_mask:0xf bank_mask:0xf
  v_and_b32_dpp v19, v27, v9 row_newbcast:12 row_mask:0xf bank_mask:0xf
  v_mfma_f32_16x16x32_bf16 v[10:13], a[8:11], v[28:31], v[10:13]
  s_nop 0
  v_mfma_f32_16x16x32_bf16 v[10:13], a[12:15], v[16:19], v[10:13]
  s_cmp_lg_u32 s86, 0
  s_cbranch_scc1 L_nx0
  s_waitcnt vmcnt(8)
  s_cmp_lg_u32 s81, 0
  s_cbranch_scc1 L_have0
  s_lshl_b32 s90, s82, 2
  s_add_u32 s90, s90, 640
  v_mov_b32 v20, s90
L_mb0:
  ds_read_b32 v21, v20
  s_waitcnt lgkmcnt(0)
  v_readfirstlane_b32 s90, v21
  s_cmp_lg_u32 s90, -1
  s_cbranch_scc1 L_got0
  s_sub_u32 s88, s88, 1
  s_cmp_lg_u32 s88, 0
  s_cbranch_scc1 L_mb0
  s_mov_b32 s90, 256
L_got0:
  s_add_u32 s82, s82, 1
  s_and_b32 s80, s90, 0xffff
  s_bfe_u32 s81, s90, 0x80010
  s_lshr_b32 s62, s90, 24
  s_mov_b32 s83, s81
  s_cmp_lt_u32 s80, 256
  s_cbranch_scc1 L_ok0
L_drain0:
  s_mov_b32 s86, 1
  s_mov_b32 s89, 5
  s_mov_b64 exec, 1
  v_mov_b32 v20, 512
  v_mov_b32 v21, 1
  ds_add_u32 v20, v21
  s_mov_b64 exec, -1
  s_branch L_nx0
L_ok0:
  s_add_u32 s80, s80, s39
L_have0:
  s_lshr_b32 s84, s80, 4
  s_lshl_b32 s84, s84, 1
  s_add_u32 s84, s84, s80
  s_and_b32 s84, s84, 15
  s_andn2_b32 s85, s80, 15
  s_or_b32 s84, s84, s85
  s_lshl_b32 s38, s84, 12
  s_mov_b32 s56, s62
  s_cmp_eq_u32 s62, 0
  s_cbranch_scc1 L_full0
  s_lshr_b32 s63, s62, 1
  s_lshl_b32 s63, s63, 11
  s_add_u32 s38, s38, s63
  s_add_u32 s50, s38, 2048
  s_mov_b32 s54, s50
L_full0:
  s_add_u32 s80, s80, 16
  s_sub_u32 s81, s81, 1
  buffer_load_dwordx4 v[40:43], v1, s[48:51], s38 offen offset:0 nt
  buffer_load_dwordx4 v[44:47], v1, s[48:51], s38 offen offset:1024 nt
  buffer_load_dwordx4 v[48:51], v1, s[48:51], s38 offen offset:2048 nt
  buffer_load_dwordx4 v[52:55], v1, s[48:51], s38 offen offset:3072 nt
  s_cmp_le_u32 s81, 1
  s_cbranch_scc0 L_nr0
  s_add_u32 s90, s82, 1
  s_cmp_eq_u32 s83, 1
  s_addc_u32 s90, s90, 0
  s_mov_b64 exec, 1
  v_mov_b32 v21, s90
  ds_max_u32 v36, v21
  s_mov_b64 exec, -1
L_nr0:
  s_waitcnt vmcnt(8)
  buffer_load_dwordx4 a[0:3], v1, s[52:55], s38 offen offset:0 nt
  buffer_load_dwordx4 a[4:7], v1, s[52:55], s38 offen offset:1024 nt
  buffer_load_dwordx4 a[8:11], v1, s[52:55], s38 offen offset:2048 nt
  buffer_load_dwordx4 a[12:15], v1, s[52:55], s38 offen offset:3072 nt
L_nx0:
  s_cmp_eq_u32 s86, 0
  s_cbranch_scc1 L_nw1
  s_cmp_eq_u32 s89, 0
  s_cbranch_scc1 L_sdone
  s_sub_u32 s89, s89, 1
  s_cmp_ge_u32 s89, 2
  s_cbranch_scc1 L_dw1
  s_cmp_eq_u32 s89, 1
  s_cbranch_scc1 L_w81
  s_waitcnt vmcnt(0)
  s_branch L_go1
L_w81:
  s_waitcnt vmcnt(8)
  s_branch L_go1
L_dw1:
  s_waitcnt vmcnt(16)
  s_branch L_go1
L_nw1:
  s_waitcnt vmcnt(40)
L_go1:
  v_dot2_f32_bf16 v16, v56, v2, 0
  v_dot2_f32_bf16 v17, v60, v2, 0
  v_dot2_f32_bf16 v18, v64, v2, 0
  v_dot2_f32_bf16 v19, v68, v2, 0
  v_dot2c_f32_bf16 v16, v57, v3
  v_dot2c_f32_bf16 v17, v61, v3
  v_dot2c_f32_bf16 v18, v65, v3
  v_dot2c_f32_bf16 v19, v69, v3
  v_dot2c_f32_bf16 v16, v58, v4
  v_dot2c_f32_bf16 v17, v62, v4
  v_dot2c_f32_bf16 v18, v66, v4
  v_dot2c_f32_bf16 v19, v70, v4
  v_dot2c_f32_bf16 v16, v59, v5
  v_dot2c_f32_bf16 v17, v63, v5
  v_dot2c_f32_bf16 v18, v67, v5
  v_dot2c_f32_bf16 v19, v71, v5
  v_add_f32_dpp v20, v16, v16 row_ror:8 row_mask:0xf bank_mask:0x3
  s_nop 0
  v_add_f32_dpp v21, v18, v18 row_ror:8 row_mask:0xf bank_mask:0x3
  v_add_f32_dpp v20, v17, v17 row_ror:8 row_mask:0xf bank_mask:0xc
  s_nop 0
  v_add_f32_dpp v21, v19, v19 row_ror:8 row_mask:0xf bank_mask:0xc
  v_add_f32_dpp v22, v20, v20 row_shl:4 row_mask:0xf bank_mask:0x5
  s_nop 1
  v_add_f32_dpp v22, v21, v21 row_shr:4 row_mask:0xf bank_mask:0xa
  s_nop 1
  v_add_f32_dpp v22, v22, v22 quad_perm:[1,0,3,2] row_mask:0xf bank_mask:0xf
  s_nop 1
  v_add_f32_dpp v22, v22, v22 quad_perm:[2,3,0,1] row_mask:0xf bank_mask:0xf
  v_cvt_pk_bf16_f32 v23, v22, v22
  v_and_b32 v23, 0xffff0000, v23
  v_mul_f32 v23, s40, v23
  v_cvt_pk_bf16_f32 v23, v23, v23
  v_and_b32 v23, 0xffff0000, v23
  s_cmp_eq_u32 s57, 0
  s_cbranch_scc1 L_nh1
  v_cndmask_b32 v23, v23, v35, s[42:43]
L_nh1:
  v_cmp_lt_f32 vcc, v14, v23
  s_cmp_lg_u64 vcc, 0
  s_cbranch_scc0 L_nomax1
  v_max_f32_dpp v24, v23, v23 row_ror:4 row_mask:0xf bank_mask:0xf
  s_nop 1
  v_max_f32_dpp v24, v24, v24 row_ror:8 row_mask:0xf bank_mask:0xf
  v_mov_b32 v25, v24
  s_nop 1
  v_permlane16_swap_b32 v24, v25
  v_max_f32 v24, v24, v25
  v_mov_b32 v25, v24
  s_nop 1
  v_permlane32_swap_b32 v24, v25
  v_max3_f32 v24, v24, v25, v14
  v_sub_f32 v25, v14, v24
  v_mul_f32 v25, s41, v25
  v_exp_f32 v25, v25
  v_mov_b32 v14, v24
  v_mul_f32 v15, v15, v25
  v_mul_f32 v10, v10, v25
  v_mul_f32 v11, v11, v25
  v_mul_f32 v12, v12, v25
  v_mul_f32 v13, v13, v25
L_nomax1:
  v_sub_f32 v26, v23, v14
  v_mul_f32 v26, s41, v26
  v_exp_f32 v26, v26
  s_nop 0
  v_cvt_pk_bf16_f32 v27, v26, v26
  v_add_f32 v15, v15, v26
  s_nop 0
  v_and_b32_dpp v28, v27, v6 row_newbcast:0 row_mask:0xf bank_mask:0xf
  v_and_b32_dpp v29, v27, v7 row_newbcast:0 row_mask:0xf bank_mask:0xf
  v_and_b32_dpp v30, v27, v8 row_newbcast:0 row_mask:0xf bank_mask:0xf
  v_and_b32_dpp v31, v27, v9 row_newbcast:0 row_mask:0xf bank_mask:0xf
  v_and_b32_dpp v16, v27, v6 row_newbcast:8 row_mask:0xf bank_mask:0xf
  v_and_b32_dpp v17, v27, v7 row_newbcast:8 row_mask:0xf bank_mask:0xf
  v_and_b32_dpp v18, v27, v8 row_newbcast:8 row_mask:0xf bank_mask:0xf
  v_and_b32_dpp v19, v27, v9 row_newbcast:8 row_mask:0xf bank_mask:0xf
  v_mfma_f32_16x16x32_bf16 v[10:13], a[16:19], v[28:31], v[10:13]
  v_and_b32_dpp v28, v27, v6 row_newbcast:4 row_mask:0xf bank_mask:0xf
  v_and_b32_dpp v29, v27, v7 row_newbcast:4 row_mask:0xf bank_mask:0xf
  v_and_b32_dpp v30, v27, v8 row_newbcast:4 row_mask:0xf bank_mask:0xf
  v_and_b32_dpp v31, v27, v9 row_newbcast:4 row_mask:0xf bank_mask:0xf
  v_mfma_f32_16x16x32_bf16 v[10:13], a[20:23], v[16:19], v[10:13]
  v_and_b32_dpp v16, v27, v6 row_newbcast:12 row_mask:0xf bank_mask:0xf
  v_and_b32_dpp v17, v27, v7 row_newbcast:12 row_mask:0xf bank_mask:0xf
  v_and_b32_dpp v18, v27, v8 row_newbcast:12 row_mask:0xf bank_mask:0xf
  v_and_b32_dpp v19, v27, v9 row_newbcast:12 row_mask:0xf bank_mask:0xf
  v_mfma_f32_16x16x32_bf16 v[10:13], a[24:27], v[28:31], v[10:13]
  s_nop 0
  v_mfma_f32_16x16x32_bf16 v[10:13], a[28:31], v[16:19], v[10:13]
  s_cmp_lg_u32 s86, 0
  s_cbranch_scc1 L_nx1
  s_waitcnt vmcnt(8)
  s_cmp_lg_u32 s81, 0
  s_cbranch_scc1 L_have1
  s_lshl_b32 s90, s82, 2
  s_add_u32 s90, s90, 640
  v_mov_b32 v20, s90
L_mb1:
  ds_read_b32 v21, v20
  s_waitcnt lgkmcnt(0)
  v_readfirstlane_b32 s90, v21
  s_cmp_lg_u32 s90, -1
  s_cbranch_scc1 L_got1
  s_sub_u32 s88, s88, 1
  s_cmp_lg_u32 s88, 0
  s_cbranch_scc1 L_mb1
  s_mov_b32 s90, 256
L_got1:
  s_add_u32 s82, s82, 1
  s_and_b32 s80, s90, 0xffff
  s_bfe_u32 s81, s90, 0x80010
  s_lshr_b32 s62, s90, 24
  s_mov_b32 s83, s81
  s_cmp_lt_u32 s80, 256
  s_cbranch_scc1 L_ok1
L_drain1:
  s_mov_b32 s86, 1
  s_mov_b32 s89, 5
  s_mov_b64 exec, 1
  v_mov_b32 v20, 512
  v_mov_b32 v21, 1
  ds_add_u32 v20, v21
  s_mov_b64 exec, -1
  s_branch L_nx1
L_ok1:
  s_add_u32 s80, s80, s39
L_have1:
  s_lshr_b32 s84, s80, 4
  s_lshl_b32 s84, s84, 1
  s_add_u32 s84, s84, s80
  s_and_b32 s84, s84, 15
  s_andn2_b32 s85, s80, 15
  s_or_b32 s84, s84, s85
  s_lshl_b32 s38, s84, 12
  s_mov_b32 s57, s62
  s_cmp_eq_u32 s62, 0
  s_cbranch_scc1 L_full1
  s_lshr_b32 s63, s62, 1
  s_lshl_b32 s63, s63, 11
  s_add_u32 s38, s38, s63
  s_add_u32 s50, s38, 2048
  s_mov_b32 s54, s50
L_full1:
  s_add_u32 s80, s80, 16
  s_sub_u32 s81, s81, 1
  buffer_load_dwordx4 v[56:59], v1, s[48:51], s38 offen offset:0 nt
  buffer_load_dwordx4 v[60:63], v1, s[48:51], s38 offen offset:1024 nt
  buffer_load_dwordx4 v[64:67], v1, s[48:51], s38 offen offset:2048 nt
  buffer_load_dwordx4 v[68:71], v1, s[48:51], s38 offen offset:3072 nt
  s_cmp_le_u32 s81, 1
  s_cbranch_scc0 L_nr1
  s_add_u32 s90, s82, 1
  s_cmp_eq_u32 s83, 1
  s_addc_u32 s90, s90, 0
  s_mov_b64 exec, 1
  v_mov_b32 v21, s90
  ds_max_u32 v36, v21
  s_mov_b64 exec, -1
L_nr1:
  s_waitcnt vmcnt(8)
  buffer_load_dwordx4 a[16:19], v1, s[52:55], s38 offen offset:0 nt
  buffer_load_dwordx4 a[20:23], v1, s[52:55], s38 offen offset:1024 nt
  buffer_load_dwordx4 a[24:27], v1, s[52:55], s38 offen offset:2048 nt
  buffer_load_dwordx4 a[28:31], v1, s[52:55], s38 offen offset:3072 nt
L_nx1:
  s_cmp_eq_u32 s86, 0
  s_cbranch_scc1 L_nw2
  s_cmp_eq_u32 s89, 0
  s_cbranch_scc1 L_sdone
  s_sub_u32 s89, s89, 1
  s_cmp_ge_u32 s89, 2
  s_cbranch_scc1 L_dw2
  s_cmp_eq_u32 s89, 1
  s_cbranch_scc1 L_w82
  s_waitcnt vmcnt(0)
  s_branch L_go2
L_w82:
  s_waitcnt vmcnt(8)
  s_branch L_go2
L_dw2:
  s_waitcnt vmcnt(16)
  s_branch L_go2
L_nw2:
  s_waitcnt vmcnt(40)
L_go2:
  v_dot2_f32_bf16 v16, v72, v2, 0
  v_dot2_f32_bf16 v17, v76, v2, 0
  v_dot2_f32_bf16 v18, v80, v2, 0
  v_dot2_f32_bf16 v19, v84, v2, 0
  v_dot2c_f32_bf16 v16, v73, v3
  v_dot2c_f32_bf16 v17, v77, v3
  v_dot2c_f32_bf16 v18, v81, v3
  v_dot2c_f32_bf16 v19, v85, v3
  v_dot2c_f32_bf16 v16, v74, v4
  v_dot2c_f32_bf16 v17, v78, v4
  v_dot2c_f32_bf16 v18, v82, v4
  v_dot2c_f32_bf16 v19, v86, v4
  v_dot2c_f32_bf16 v16, v75, v5
  v_dot2c_f32_bf16 v17, v79, v5
  v_dot2c_f32_bf16 v18, v83, v5
  v_dot2c_f32_bf16 v19, v87, v5
  v_add_f32_dpp v20, v16, v16 row_ror:8 row_mask:0xf bank_mask:0x3
  s_nop 0
  v_add_f32_dpp v21, v18, v18 row_ror:8 row_mask:0xf bank_mask:0x3
  v_add_f32_dpp v20, v17, v17 row_ror:8 row_mask:0xf bank_mask:0xc
  s_nop 0
  v_add_f32_dpp v21, v19, v19 row_ror:8 row_mask:0xf bank_mask:0xc
  v_add_f32_dpp v22, v20, v20 row_shl:4 row_mask:0xf bank_mask:0x5
  s_nop 1
  v_add_f32_dpp v22, v21, v21 row_shr:4 row_mask:0xf bank_mask:0xa
  s_nop 1
  v_add_f32_dpp v22, v22, v22 quad_perm:[1,0,3,2] row_mask:0xf bank_mask:0xf
  s_nop 1
  v_add_f32_dpp v22, v22, v22 quad_perm:[2,3,0,1] row_mask:0xf bank_mask:0xf
  v_cvt_pk_bf16_f32 v23, v22, v22
  v_and_b32 v23, 0xffff0000, v23
  v_mul_f32 v23, s40, v23
  v_cvt_pk_bf16_f32 v23, v23, v23
  v_and_b32 v23, 0xffff0000, v23
  s_cmp_eq_u32 s58, 0
  s_cbranch_scc1 L_nh2
  v_cndmask_b32 v23, v23, v35, s[42:43]
L_nh2:
  v_cmp_lt_f32 vcc, v14, v23
  s_cmp_lg_u64 vcc, 0
  s_cbranch_scc0 L_nomax2
  v_max_f32_dpp v24, v23, v23 row_ror:4 row_mask:0xf bank_mask:0xf
  s_nop 1
  v_max_f32_dpp v24, v24, v24 row_ror:8 row_mask:0xf bank_mask:0xf
  v_mov_b32 v25, v24
  s_nop 1
  v_permlane16_swap_b32 v24, v25
  v_max_f32 v24, v24, v25
  v_mov_b32 v25, v24
  s_nop 1
  v_permlane32_swap_b32 v24, v25
  v_max3_f32 v24, v24, v25, v14
  v_sub_f32 v25, v14, v24
  v_mul_f32 v25, s41, v25
  v_exp_f32 v25, v25
  v_mov_b32 v14, v24
  v_mul_f32 v15, v15, v25
  v_mul_f32 v10, v10, v25
  v_mul_f32 v11, v11, v25
  v_mul_f32 v12, v12, v25
  v_mul_f32 v13, v13, v25
L_nomax2:
  v_sub_f32 v26, v23, v14
  v_mul_f32 v26, s41, v26
  v_exp_f32 v26, v26
  s_nop 0
  v_cvt_pk_bf16_f32 v27, v26, v26
  v_add_f32 v15, v15, v26
  s_nop 0
  v_and_b32_dpp v28, v27, v6 row_newbcast:0 row_mask:0xf bank_mask:0xf
  v_and_b32_dpp v29, v27, v7 row_newbcast:0 row_mask:0xf bank_mask:0xf
  v_and_b32_dpp v30, v27, v8 row_newbcast:0 row_mask:0xf bank_mask:0xf
  v_and_b32_dpp v31, v27, v9 row_newbcast:0 row_mask:0xf bank_mask:0xf
  v_and_b32_dpp v16, v27, v6 row_newbcast:8 row_mask:0xf bank_mask:0xf
  v_and_b32_dpp v17, v27, v7 row_newbcast:8 row_mask:0xf bank_mask:0xf
  v_and_b32_dpp v18, v27, v8 row_newbcast:8 row_mask:0xf bank_mask:0xf
  v_and_b32_dpp v19, v27, v9 row_newbcast:8 row_mask:0xf bank_mask:0xf
  v_mfma_f32_16x16x32_bf16 v[10:13], a[32:35], v[28:31], v[10:13]
  v_and_b32_dpp v28, v27, v6 row_newbcast:4 row_mask:0xf bank_mask:0xf
  v_and_b32_dpp v29, v27, v7 row_newbcast:4 row_mask:0xf bank_mask:0xf
  v_and_b32_dpp v30, v27, v8 row_newbcast:4 row_mask:0xf bank_mask:0xf
  v_and_b32_dpp v31, v27, v9 row_newbcast:4 row_mask:0xf bank_mask:0xf
  v_mfma_f32_16x16x32_bf16 v[10:13], a[36:39], v[16:19], v[10:13]
  v_and_b32_dpp v16, v27, v6 row_newbcast:12 row_mask:0xf bank_mask:0xf
  v_and_b32_dpp v17, v27, v7 row_newbcast:12 row_mask:0xf bank_mask:0xf
  v_and_b32_dpp v18, v27, v8 row_newbcast:12 row_mask:0xf bank_mask:0xf
  v_and_b32_dpp v19, v27, v9 row_newbcast:12 row_mask:0xf bank_mask:0xf
  v_mfma_f32_16x16x32_bf16 v[10:13], a[40:43], v[28:31], v[10:13]
  s_nop 0
  v_mfma_f32_16x16x32_bf16 v[10:13], a[44:47], v[16:19], v[10:13]
  s_cmp_lg_u32 s86, 0
  s_cbranch_scc1 L_nx2
  s_waitcnt vmcnt(8)
  s_cmp_lg_u32 s81, 0
  s_cbranch_scc1 L_have2
  s_lshl_b32 s90, s82, 2
  s_add_u32 s90, s90, 640
  v_mov_b32 v20, s90
L_mb2:
  ds_read_b32 v21, v20
  s_waitcnt lgkmcnt(0)
  v_readfirstlane_b32 s90, v21
  s_cmp_lg_u32 s90, -1
  s_cbranch_scc1 L_got2
  s_sub_u32 s88, s88, 1
  s_cmp_lg_u32 s88, 0
  s_cbranch_scc1 L_mb2
  s_mov_b32 s90, 256
L_got2:
  s_add_u32 s82, s82, 1
  s_and_b32 s80, s90, 0xffff
  s_bfe_u32 s81, s90, 0x80010
  s_lshr_b32 s62, s90, 24
  s_mov_b32 s83, s81
  s_cmp_lt_u32 s80, 256
  s_cbranch_scc1 L_ok2
L_drain2:
  s_mov_b32 s86, 1
  s_mov_b32 s89, 5
  s_mov_b64 exec, 1
  v_mov_b32 v20, 512
  v_mov_b32 v21, 1
  ds_add_u32 v20, v21
  s_mov_b64 exec, -1
  s_branch L_nx2
L_ok2:
  s_add_u32 s80, s80, s39
L_have2:
  s_lshr_b32 s84, s80, 4
  s_lshl_b32 s84, s84, 1
  s_add_u32 s84, s84, s80
  s_and_b32 s84, s84, 15
  s_andn2_b32 s85, s80, 15
  s_or_b32 s84, s84, s85
  s_lshl_b32 s38, s84, 12
  s_mov_b32 s58, s62
  s_cmp_eq_u32 s62, 0
  s_cbranch_scc1 L_full2
  s_lshr_b32 s63, s62, 1
  s_lshl_b32 s63, s63, 11
  s_add_u32 s38, s38, s63
  s_add_u32 s50, s38, 2048
  s_mov_b32 s54, s50
L_full2:
  s_add_u32 s80, s80, 16
  s_sub_u32 s81, s81, 1
  buffer_load_dwordx4 v[72:75], v1, s[48:51], s38 offen offset:0 nt
  buffer_load_dwordx4 v[76:79], v1, s[48:51], s38 offen offset:1024 nt
  buffer_load_dwordx4 v[80:83], v1, s[48:51], s38 offen offset:2048 nt
  buffer_load_dwordx4 v[84:87], v1, s[48:51], s38 offen offset:3072 nt
  s_cmp_le_u32 s81, 1
  s_cbranch_scc0 L_nr2
  s_add_u32 s90, s82, 1
  s_cmp_eq_u32 s83, 1
  s_addc_u32 s90, s90, 0
  s_mov_b64 exec, 1
  v_mov_b32 v21, s90
  ds_max_u32 v36, v21
  s_mov_b64 exec, -1
L_nr2:
  s_waitcnt vmcnt(8)
  buffer_load_dwordx4 a[32:35], v1, s[52:55], s38 offen offset:0 nt
  buffer_load_dwordx4 a[36:39], v1, s[52:55], s38 offen offset:1024 nt
  buffer_load_dwordx4 a[40:43], v1, s[52:55], s38 offen offset:2048 nt
  buffer_load_dwordx4 a[44:47], v1, s[52:55], s38 offen offset:3072 nt
L_nx2:
  s_cmp_eq_u32 s86, 0
  s_cbranch_scc1 L_nw3
  s_cmp_eq_u32 s89, 0
  s_cbranch_scc1 L_sdone
  s_sub_u32 s89, s89, 1
  s_cmp_ge_u32 s89, 2
  s_cbranch_scc1 L_dw3
  s_cmp_eq_u32 s89, 1
  s_cbranch_scc1 L_w83
  s_waitcnt vmcnt(0)
  s_branch L_go3
L_w83:
  s_waitcnt vmcnt(8)
  s_branch L_go3
L_dw3:
  s_waitcnt vmcnt(16)
  s_branch L_go3
L_nw3:
  s_waitcnt vmcnt(40)
L_go3:
  v_dot2_f32_bf16 v16, v88, v2, 0
  v_dot2_f32_bf16 v17, v92, v2, 0
  v_dot2_f32_bf16 v18, v96, v2, 0
  v_dot2_f32_bf16 v19, v100, v2, 0
  v_dot2c_f32_bf16 v16, v89, v3
  v_dot2c_f32_bf16 v17, v93, v3
  v_dot2c_f32_bf16 v18, v97, v3
  v_dot2c_f32_bf16 v19, v101, v3
  v_dot2c_f32_bf16 v16, v90, v4
  v_dot2c_f32_bf16 v17, v94, v4
  v_dot2c_f32_bf16 v18, v98, v4
  v_dot2c_f32_bf16 v19, v102, v4
  v_dot2c_f32_bf16 v16, v91, v5
  v_dot2c_f32_bf16 v17, v95, v5
  v_dot2c_f32_bf16 v18, v99, v5
  v_dot2c_f32_bf16 v19, v103, v5
  v_add_f32_dpp v20, v16, v16 row_ror:8 row_mask:0xf bank_mask:0x3
  s_nop 0
  v_add_f32_dpp v21, v18, v18 row_ror:8 row_mask:0xf bank_mask:0x3
  v_add_f32_dpp v20, v17, v17 row_ror:8 row_mask:0xf bank_mask:0xc
  s_nop 0
  v_add_f32_dpp v21, v19, v19 row_ror:8 row_mask:0xf bank_mask:0xc
  v_add_f32_dpp v22, v20, v20 row_shl:4 row_mask:0xf bank_mask:0x5
  s_nop 1
  v_add_f32_dpp v22, v21, v21 row_shr:4 row_mask:0xf bank_mask:0xa
  s_nop 1
  v_add_f32_dpp v22, v22, v22 quad_perm:[1,0,3,2] row_mask:0xf bank_mask:0xf
  s_nop 1
  v_add_f32_dpp v22, v22, v22 quad_perm:[2,3,0,1] row_mask:0xf bank_mask:0xf
  v_cvt_pk_bf16_f32 v23, v22, v22
  v_and_b32 v23, 0xffff0000, v23
  v_mul_f32 v23, s40, v23
  v_cvt_pk_bf16_f32 v23, v23, v23
  v_and_b32 v23, 0xffff0000, v23
  s_cmp_eq_u32 s59, 0
  s_cbranch_scc1 L_nh3
  v_cndmask_b32 v23, v23, v35, s[42:43]
L_nh3:
  v_cmp_lt_f32 vcc, v14, v23
  s_cmp_lg_u64 vcc, 0
  s_cbranch_scc0 L_nomax3
  v_max_f32_dpp v24, v23, v23 row_ror:4 row_mask:0xf bank_mask:0xf
  s_nop 1
  v_max_f32_dpp v24, v24, v24 row_ror:8 row_mask:0xf bank_mask:0xf
  v_mov_b32 v25, v24
  s_nop 1
  v_permlane16_swap_b32 v24, v25
  v_max_f32 v24, v24, v25
  v_mov_b32 v25, v24
  s_nop 1
  v_permlane32_swap_b32 v24, v25
  v_max3_f32 v24, v24, v25, v14
  v_sub_f32 v25, v14, v24
  v_mul_f32 v25, s41, v25
  v_exp_f32 v25, v25
  v_mov_b32 v14, v24
  v_mul_f32 v15, v15, v25
  v_mul_f32 v10, v10, v25
  v_mul_f32 v11, v11, v25
  v_mul_f32 v12, v12, v25
  v_mul_f32 v13, v13, v25
L_nomax3:
  v_sub_f32 v26, v23, v14
  v_mul_f32 v26, s41, v26
  v_exp_f32 v26, v26
  s_nop 0
  v_cvt_pk_bf16_f32 v27, v26, v26
  v_add_f32 v15, v15, v26
  s_nop 0
  v_and_b32_dpp v28, v27, v6 row_newbcast:0 row_mask:0xf bank_mask:0xf
  v_and_b32_dpp v29, v27, v7 row_newbcast:0 row_mask:0xf bank_mask:0xf
  v_and_b32_dpp v30, v27, v8 row_newbcast:0 row_mask:0xf bank_mask:0xf
  v_and_b32_dpp v31, v27, v9 row_newbcast:0 row_mask:0xf bank_mask:0xf
  v_and_b32_dpp v16, v27, v6 row_newbcast:8 row_mask:0xf bank_mask:0xf
  v_and_b32_dpp v17, v27, v7 row_newbcast:8 row_mask:0xf bank_mask:0xf
  v_and_b32_dpp v18, v27, v8 row_newbcast:8 row_mask:0xf bank_mask:0xf
  v_and_b32_dpp v19, v27, v9 row_newbcast:8 row_mask:0xf bank_mask:0xf
  v_mfma_f32_16x16x32_bf16 v[10:13], a[48:51], v[28:31], v[10:13]
  v_and_b32_dpp v28, v27, v6 row_newbcast:4 row_mask:0xf bank_mask:0xf
  v_and_b32_dpp v29, v27, v7 row_newbcast:4 row_mask:0xf bank_mask:0xf
  v_and_b32_dpp v30, v27, v8 row_newbcast:4 row_mask:0xf bank_mask:0xf
  v_and_b32_dpp v31, v27, v9 row_newbcast:4 row_mask:0xf bank_mask:0xf
  v_mfma_f32_16x16x32_bf16 v[10:13], a[52:55], v[16:19], v[10:13]
  v_and_b32_dpp v16, v27, v6 row_newbcast:12 row_mask:0xf bank_mask:0xf
  v_and_b32_dpp v17, v27, v7 row_newbcast:12 row_mask:0xf bank_mask:0xf
  v_and_b32_dpp v18, v27, v8 row_newbcast:12 row_mask:0xf bank_mask:0xf
  v_and_b32_dpp v19, v27, v9 row_newbcast:12 row_mask:0xf bank_mask:0xf
  v_mfma_f32_16x16x32_bf16 v[10:13], a[56:59], v[28:31], v[10:13]
  s_nop 0
  v_mfma_f32_16x16x32_bf16 v[10:13], a[60:63], v[16:19], v[10:13]
  s_cmp_lg_u32 s86, 0
  s_cbranch_scc1 L_nx3
  s_waitcnt vmcnt(8)
  s_cmp_lg_u32 s81, 0
  s_cbranch_scc1 L_have3
  s_lshl_b32 s90, s82, 2
  s_add_u32 s90, s90, 640
  v_mov_b32 v20, s90
L_mb3:
  ds_read_b32 v21, v20
  s_waitcnt lgkmcnt(0)
  v_readfirstlane_b32 s90, v21
  s_cmp_lg_u32 s90, -1
  s_cbranch_scc1 L_got3
  s_sub_u32 s88, s88, 1
  s_cmp_lg_u32 s88, 0
  s_cbranch_scc1 L_mb3
  s_mov_b32 s90, 256
L_got3:
  s_add_u32 s82, s82, 1
  s_and_b32 s80, s90, 0xffff
  s_bfe_u32 s81, s90, 0x80010
  s_lshr_b32 s62, s90, 24
  s_mov_b32 s83, s81
  s_cmp_lt_u32 s80, 256
  s_cbranch_scc1 L_ok3
L_drain3:
  s_mov_b32 s86, 1
  s_mov_b32 s89, 5
  s_mov_b64 exec, 1
  v_mov_b32 v20, 512
  v_mov_b32 v21, 1
  ds_add_u32 v20, v21
  s_mov_b64 exec, -1
  s_branch L_nx3
L_ok3:
  s_add_u32 s80, s80, s39
L_have3:
  s_lshr_b32 s84, s80, 4
  s_lshl_b32 s84, s84, 1
  s_add_u32 s84, s84, s80
  s_and_b32 s84, s84, 15
  s_andn2_b32 s85, s80, 15
  s_or_b32 s84, s84, s85
  s_lshl_b32 s38, s84, 12
  s_mov_b32 s59, s62
  s_cmp_eq_u32 s62, 0
  s_cbranch_scc1 L_full3
  s_lshr_b32 s63, s62, 1
  s_lshl_b32 s63, s63, 11
  s_add_u32 s38, s38, s63
  s_add_u32 s50, s38, 2048
  s_mov_b32 s54, s50
L_full3:
  s_add_u32 s80, s80, 16
  s_sub_u32 s81, s81, 1
  buffer_load_dwordx4 v[88:91], v1, s[48:51], s38 offen offset:0 nt
  buffer_load_dwordx4 v[92:95], v1, s[48:51], s38 offen offset:1024 nt
  buffer_load_dwordx4 v[96:99], v1, s[48:51], s38 offen offset:2048 nt
  buffer_load_dwordx4 v[100:103], v1, s[48:51], s38 offen offset:3072 nt
  s_cmp_le_u32 s81, 1
  s_cbranch_scc0 L_nr3
  s_add_u32 s90, s82, 1
  s_cmp_eq_u32 s83, 1
  s_addc_u32 s90, s90, 0
  s_mov_b64 exec, 1
  v_mov_b32 v21, s90
  ds_max_u32 v36, v21
  s_mov_b64 exec, -1
L_nr3:
  s_waitcnt vmcnt(8)
  buffer_load_dwordx4 a[48:51], v1, s[52:55], s38 offen offset:0 nt
  buffer_load_dwordx4 a[52:55], v1, s[52:55], s38 offen offset:1024 nt
  buffer_load_dwordx4 a[56:59], v1, s[52:55], s38 offen offset:2048 nt
  buffer_load_dwordx4 a[60:63], v1, s[52:55], s38 offen offset:3072 nt
L_nx3:
  s_cmp_eq_u32 s86, 0
  s_cbranch_scc1 L_nw4
  s_cmp_eq_u32 s89, 0
  s_cbranch_scc1 L_sdone
  s_sub_u32 s89, s89, 1
  s_cmp_ge_u32 s89, 2
  s_cbranch_scc1 L_dw4
  s_cmp_eq_u32 s89, 1
  s_cbranch_scc1 L_w84
  s_waitcnt vmcnt(0)
  s_branch L_go4
L_w84:
  s_waitcnt vmcnt(8)
  s_branch L_go4
L_dw4:
  s_waitcnt vmcnt(16)
  s_branch L_go4
L_nw4:
  s_waitcnt vmcnt(40)
L_go4:
  v_dot2_f32_bf16 v16, v104, v2, 0
  v_dot2_f32_bf16 v17, v108, v2, 0
  v_dot2_f32_bf16 v18, v112, v2, 0
  v_dot2_f32_bf16 v19, v116, v2, 0
  v_dot2c_f32_bf16 v16, v105, v3
  v_dot2c_f32_bf16 v17, v109, v3
  v_dot2c_f32_bf16 v18, v113, v3
  v_dot2c_f32_bf16 v19, v117, v3
  v_dot2c_f32_bf16 v16, v106, v4
  v_dot2c_f32_bf16 v17, v110, v4
  v_dot2c_f32_bf16 v18, v114, v4
  v_dot2c_f32_bf16 v19, v118, v4
  v_dot2c_f32_bf16 v16, v107, v5
  v_dot2c_f32_bf16 v17, v111, v5
  v_dot2c_f32_bf16 v18, v115, v5
  v_dot2c_f32_bf16 v19, v119, v5
  v_add_f32_dpp v20, v16, v16 row_ror:8 row_mask:0xf bank_mask:0x3
  s_nop 0
  v_add_f32_dpp v21, v18, v18 row_ror:8 row_mask:0xf bank_mask:0x3
  v_add_f32_dpp v20, v17, v17 row_ror:8 row_mask:0xf bank_mask:0xc
  s_nop 0
  v_add_f32_dpp v21, v19, v19 row_ror:8 row_mask:0xf bank_mask:0xc
  v_add_f32_dpp v22, v20, v20 row_shl:4 row_mask:0xf bank_mask:0x5
  s_nop 1
  v_add_f32_dpp v22, v21, v21 row_shr:4 row_mask:0xf bank_mask:0xa
  s_nop 1
  v_add_f32_dpp v22, v22, v22 quad_perm:[1,0,3,2] row_mask:0xf bank_mask:0xf
  s_nop 1
  v_add_f32_dpp v22, v22, v22 quad_perm:[2,3,0,1] row_mask:0xf bank_mask:0xf
  v_cvt_pk_bf16_f32 v23, v22, v22
  v_and_b32 v23, 0xffff0000, v23
  v_mul_f32 v23, s40, v23
  v_cvt_pk_bf16_f32 v23, v23, v23
  v_and_b32 v23, 0xffff0000, v23
  s_cmp_eq_u32 s60, 0
  s_cbranch_scc1 L_nh4
  v_cndmask_b32 v23, v23, v35, s[42:43]
L_nh4:
  v_cmp_lt_f32 vcc, v14, v23
  s_cmp_lg_u64 vcc, 0
  s_cbranch_scc0 L_nomax4
  v_max_f32_dpp v24, v23, v23 row_ror:4 row_mask:0xf bank_mask:0xf
  s_nop 1
  v_max_f32_dpp v24, v24, v24 row_ror:8 row_mask:0xf bank_mask:0xf
  v_mov_b32 v25, v24
  s_nop 1
  v_permlane16_swap_b32 v24, v25
  v_max_f32 v24, v24, v25
  v_mov_b32 v25, v24
  s_nop 1
  v_permlane32_swap_b32 v24, v25
  v_max3_f32 v24, v24, v25, v14
  v_sub_f32 v25, v14, v24
  v_mul_f32 v25, s41, v25
  v_exp_f32 v25, v25
  v_mov_b32 v14, v24
  v_mul_f32 v15, v15, v25
  v_mul_f32 v10, v10, v25
  v_mul_f32 v11, v11, v25
  v_mul_f32 v12, v12, v25
  v_mul_f32 v13, v13, v25
L_nomax4:
  v_sub_f32 v26, v23, v14
  v_mul_f32 v26, s41, v26
  v_exp_f32 v26, v26
  s_nop 0
  v_cvt_pk_bf16_f32 v27, v26, v26
  v_add_f32 v15, v15, v26
  s_nop 0
  v_and_b32_dpp v28, v27, v6 row_newbcast:0 row_mask:0xf bank_mask:0xf
  v_and_b32_dpp v29, v27, v7 row_newbcast:0 row_mask:0xf bank_mask:0xf
  v_and_b32_dpp v30, v27, v8 row_newbcast:0 row_mask:0xf bank_mask:0xf
  v_and_b32_dpp v31, v27, v9 row_newbcast:0 row_mask:0xf bank_mask:0xf
  v_and_b32_dpp v16, v27, v6 row_newbcast:8 row_mask:0xf bank_mask:0xf
  v_and_b32_dpp v17, v27, v7 row_newbcast:8 row_mask:0xf bank_mask:0xf
  v_and_b32_dpp v18, v27, v8 row_newbcast:8 row_mask:0xf bank_mask:0xf
  v_and_b32_dpp v19, v27, v9 row_newbcast:8 row_mask:0xf bank_mask:0xf
  v_mfma_f32_16x16x32_bf16 v[10:13], a[64:67], v[28:31], v[10:13]
  v_and_b32_dpp v28, v27, v6 row_newbcast:4 row_mask:0xf bank_mask:0xf
  v_and_b32_dpp v29, v27, v7 row_newbcast:4 row_mask:0xf bank_mask:0xf
  v_and_b32_dpp v30, v27, v8 row_newbcast:4 row_mask:0xf bank_mask:0xf
  v_and_b32_dpp v31, v27, v9 row_newbcast:4 row_mask:0xf bank_mask:0xf
  v_mfma_f32_16x16x32_bf16 v[10:13], a[68:71], v[16:19], v[10:13]
  v_and_b32_dpp v16, v27, v6 row_newbcast:12 row_mask:0xf bank_mask:0xf
  v_and_b32_dpp v17, v27, v7 row_newbcast:12 row_mask:0xf bank_mask:0xf
  v_and_b32_dpp v18, v27, v8 row_newbcast:12 row_mask:0xf bank_mask:0xf
  v_and_b32_dpp v19, v27, v9 row_newbcast:12 row_mask:0xf bank_mask:0xf
  v_mfma_f32_16x16x32_bf16 v[10:13], a[72:75], v[28:31], v[10:13]
  s_nop 0
  v_mfma_f32_16x16x32_bf16 v[10:13], a[76:79], v[16:19], v[10:13]
  s_cmp_lg_u32 s86, 0
  s_cbranch_scc1 L_nx4
  s_waitcnt vmcnt(8)
  s_cmp_lg_u32 s81, 0
  s_cbranch_scc1 L_have4
  s_lshl_b32 s90, s82, 2
  s_add_u32 s90, s90, 640
  v_mov_b32 v20, s90
L_mb4:
  ds_read_b32 v21, v20
  s_waitcnt lgkmcnt(0)
  v_readfirstlane_b32 s90, v21
  s_cmp_lg_u32 s90, -1
  s_cbranch_scc1 L_got4
  s_sub_u32 s88, s88, 1
  s_cmp_lg_u32 s88, 0
  s_cbranch_scc1 L_mb4
  s_mov_b32 s90, 256
L_got4:
  s_add_u32 s82, s82, 1
  s_and_b32 s80, s90, 0xffff
  s_bfe_u32 s81, s90, 0x80010
  s_lshr_b32 s62, s90, 24
  s_mov_b32 s83, s81
  s_cmp_lt_u32 s80, 256
  s_cbranch_scc1 L_ok4
L_drain4:
  s_mov_b32 s86, 1
  s_mov_b32 s89, 5
  s_mov_b64 exec, 1
  v_mov_b32 v20, 512
  v_mov_b32 v21, 1
  ds_add_u32 v20, v21
  s_mov_b64 exec, -1
  s_branch L_nx4
L_ok4:
  s_add_u32 s80, s80, s39
L_have4:
  s_lshr_b32 s84, s80, 4
  s_lshl_b32 s84, s84, 1
  s_add_u32 s84, s84, s80
  s_and_b32 s84, s84, 15
  s_andn2_b32 s85, s80, 15
  s_or_b32 s84, s84, s85
  s_lshl_b32 s38, s84, 12
  s_mov_b32 s60, s62
  s_cmp_eq_u32 s62, 0
  s_cbranch_scc1 L_full4
  s_lshr_b32 s63, s62, 1
  s_lshl_b32 s63, s63, 11
  s_add_u32 s38, s38, s63
  s_add_u32 s50, s38, 2048
  s_mov_b32 s54, s50
L_full4:
  s_add_u32 s80, s80, 16
  s_sub_u32 s81, s81, 1
  buffer_load_dwordx4 v[104:107], v1, s[48:51], s38 offen offset:0 nt
  buffer_load_dwordx4 v[108:111], v1, s[48:51], s38 offen offset:1024 nt
  buffer_load_dwordx4 v[112:115], v1, s[48:51], s38 offen offset:2048 nt
  buffer_load_dwordx4 v[116:119], v1, s[48:51], s38 offen offset:3072 nt
  s_cmp_le_u32 s81, 1
  s_cbranch_scc0 L_nr4
  s_add_u32 s90, s82, 1
  s_cmp_eq_u32 s83, 1
  s_addc_u32 s90, s90, 0
  s_mov_b64 exec, 1
  v_mov_b32 v21, s90
  ds_max_u32 v36, v21
  s_mov_b64 exec, -1
L_nr4:
  s_waitcnt vmcnt(8)
  buffer_load_dwordx4 a[64:67], v1, s[52:55], s38 offen offset:0 nt
  buffer_load_dwordx4 a[68:71], v1, s[52:55], s38 offen offset:1024 nt
  buffer_load_dwordx4 a[72:75], v1, s[52:55], s38 offen offset:2048 nt
  buffer_load_dwordx4 a[76:79], v1, s[52:55], s38 offen offset:3072 nt
L_nx4:
  s_cmp_eq_u32 s86, 0
  s_cbranch_scc1 L_nw5
  s_cmp_eq_u32 s89, 0
  s_cbranch_scc1 L_sdone
  s_sub_u32 s89, s89, 1
  s_cmp_ge_u32 s89, 2
  s_cbranch_scc1 L_dw5
  s_cmp_eq_u32 s89, 1
  s_cbranch_scc1 L_w85
  s_waitcnt vmcnt(0)
  s_branch L_go5
L_w85:
  s_waitcnt vmcnt(8)
  s_branch L_go5
L_dw5:
  s_waitcnt vmcnt(16)
  s_branch L_go5
L_nw5:
  s_waitcnt vmcnt(40)
L_go5:
  v_dot2_f32_bf16 v16, v120, v2, 0
  v_dot2_f32_bf16 v17, v124, v2, 0
  v_dot2_f32_bf16 v18, v128, v2, 0
  v_dot2_f32_bf16 v19, v132, v2, 0
  v_dot2c_f32_bf16 v16, v121, v3
  v_dot2c_f32_bf16 v17, v125, v3
  v_dot2c_f32_bf16 v18, v129, v3
  v_dot2c_f32_bf16 v19, v133, v3
  v_dot2c_f32_bf16 v16, v122, v4
  v_dot2c_f32_bf16 v17, v126, v4
  v_dot2c_f32_bf16 v18, v130, v4
  v_dot2c_f32_bf16 v19, v134, v4
  v_dot2c_f32_bf16 v16, v123, v5
  v_dot2c_f32_bf16 v17, v127, v5
  v_dot2c_f32_bf16 v18, v131, v5
  v_dot2c_f32_bf16 v19, v135, v5
  v_add_f32_dpp v20, v16, v16 row_ror:8 row_mask:0xf bank_mask:0x3
  s_nop 0
  v_add_f32_dpp v21, v18, v18 row_ror:8 row_mask:0xf bank_mask:0x3
  v_add_f32_dpp v20, v17, v17 row_ror:8 row_mask:0xf bank_mask:0xc
  s_nop 0
  v_add_f32_dpp v21, v19, v19 row_ror:8 row_mask:0xf bank_mask:0xc
  v_add_f32_dpp v22, v20, v20 row_shl:4 row_mask:0xf bank_mask:0x5
  s_nop 1
  v_add_f32_dpp v22, v21, v21 row_shr:4 row_mask:0xf bank_mask:0xa
  s_nop 1
  v_add_f32_dpp v22, v22, v22 quad_perm:[1,0,3,2] row_mask:0xf bank_mask:0xf
  s_nop 1
  v_add_f32_dpp v22, v22, v22 quad_perm:[2,3,0,1] row_mask:0xf bank_mask:0xf
  v_cvt_pk_bf16_f32 v23, v22, v22
  v_and_b32 v23, 0xffff0000, v23
  v_mul_f32 v23, s40, v23
  v_cvt_pk_bf16_f32 v23, v23, v23
  v_and_b32 v23, 0xffff0000, v23
  s_cmp_eq_u32 s61, 0
  s_cbranch_scc1 L_nh5
  v_cndmask_b32 v23, v23, v35, s[42:43]
L_nh5:
  v_cmp_lt_f32 vcc, v14, v23
  s_cmp_lg_u64 vcc, 0
  s_cbranch_scc0 L_nomax5
  v_max_f32_dpp v24, v23, v23 row_ror:4 row_mask:0xf bank_mask:0xf
  s_nop 1
  v_max_f32_dpp v24, v24, v24 row_ror:8 row_mask:0xf bank_mask:0xf
  v_mov_b32 v25, v24
  s_nop 1
  v_permlane16_swap_b32 v24, v25
  v_max_f32 v24, v24, v25
  v_mov_b32 v25, v24
  s_nop 1
  v_permlane32_swap_b32 v24, v25
  v_max3_f32 v24, v24, v25, v14
  v_sub_f32 v25, v14, v24
  v_mul_f32 v25, s41, v25
  v_exp_f32 v25, v25
  v_mov_b32 v14, v24
  v_mul_f32 v15, v15, v25
  v_mul_f32 v10, v10, v25
  v_mul_f32 v11, v11, v25
  v_mul_f32 v12, v12, v25
  v_mul_f32 v13, v13, v25
L_nomax5:
  v_sub_f32 v26, v23, v14
  v_mul_f32 v26, s41, v26
  v_exp_f32 v26, v26
  s_nop 0
  v_cvt_pk_bf16_f32 v27, v26, v26
  v_add_f32 v15, v15, v26
  s_nop 0
  v_and_b32_dpp v28, v27, v6 row_newbcast:0 row_mask:0xf bank_mask:0xf
  v_and_b32_dpp v29, v27, v7 row_newbcast:0 row_mask:0xf bank_mask:0xf
  v_and_b32_dpp v30, v27, v8 row_newbcast:0 row_mask:0xf bank_mask:0xf
  v_and_b32_dpp v31, v27, v9 row_newbcast:0 row_mask:0xf bank_mask:0xf
  v_and_b32_dpp v16, v27, v6 row_newbcast:8 row_mask:0xf bank_mask:0xf
  v_and_b32_dpp v17, v27, v7 row_newbcast:8 row_mask:0xf bank_mask:0xf
  v_and_b32_dpp v18, v27, v8 row_newbcast:8 row_mask:0xf bank_mask:0xf
  v_and_b32_dpp v19, v27, v9 row_newbcast:8 row_mask:0xf bank_mask:0xf
  v_mfma_f32_16x16x32_bf16 v[10:13], a[80:83], v[28:31], v[10:13]
  v_and_b32_dpp v28, v27, v6 row_newbcast:4 row_mask:0xf bank_mask:0xf
  v_and_b32_dpp v29, v27, v7 row_newbcast:4 row_mask:0xf bank_mask:0xf
  v_and_b32_dpp v30, v27, v8 row_newbcast:4 row_mask:0xf bank_mask:0xf
  v_and_b32_dpp v31, v27, v9 row_newbcast:4 row_mask:0xf bank_mask:0xf
  v_mfma_f32_16x16x32_bf16 v[10:13], a[84:87], v[16:19], v[10:13]
  v_and_b32_dpp v16, v27, v6 row_newbcast:12 row_mask:0xf bank_mask:0xf
  v_and_b32_dpp v17, v27, v7 row_newbcast:12 row_mask:0xf bank_mask:0xf
  v_and_b32_dpp v18, v27, v8 row_newbcast:12 row_mask:0xf bank_mask:0xf
  v_and_b32_dpp v19, v27, v9 row_newbcast:12 row_mask:0xf bank_mask:0xf
  v_mfma_f32_16x16x32_bf16 v[10:13], a[88:91], v[28:31], v[10:13]
  s_nop 0
  v_mfma_f32_16x16x32_bf16 v[10:13], a[92:95], v[16:19], v[10:13]
  s_cmp_lg_u32 s86, 0
  s_cbranch_scc1 L_nx5
  s_waitcnt vmcnt(8)
  s_cmp_lg_u32 s81, 0
  s_cbranch_scc1 L_have5
  s_lshl_b32 s90, s82, 2
  s_add_u32 s90, s90, 640
  v_mov_b32 v20, s90
L_mb5:
  ds_read_b32 v21, v20
  s_waitcnt lgkmcnt(0)
  v_readfirstlane_b32 s90, v21
  s_cmp_lg_u32 s90, -1
  s_cbranch_scc1 L_got5
  s_sub_u32 s88, s88, 1
  s_cmp_lg_u32 s88, 0
  s_cbranch_scc1 L_mb5
  s_mov_b32 s90, 256
L_got5:
  s_add_u32 s82, s82, 1
  s_and_b32 s80, s90, 0xffff
  s_bfe_u32 s81, s90, 0x80010
  s_lshr_b32 s62, s90, 24
  s_mov_b32 s83, s81
  s_cmp_lt_u32 s80, 256
  s_cbranch_scc1 L_ok5
L_drain5:
  s_mov_b32 s86, 1
  s_mov_b32 s89, 5
  s_mov_b64 exec, 1
  v_mov_b32 v20, 512
  v_mov_b32 v21, 1
  ds_add_u32 v20, v21
  s_mov_b64 exec, -1
  s_branch L_nx5
L_ok5:
  s_add_u32 s80, s80, s39
L_have5:
  s_lshr_b32 s84, s80, 4
  s_lshl_b32 s84, s84, 1
  s_add_u32 s84, s84, s80
  s_and_b32 s84, s84, 15
  s_andn2_b32 s85, s80, 15
  s_or_b32 s84, s84, s85
  s_lshl_b32 s38, s84, 12
  s_mov_b32 s61, s62
  s_cmp_eq_u32 s62, 0
  s_cbranch_scc1 L_full5
  s_lshr_b32 s63, s62, 1
  s_lshl_b32 s63, s63, 11
  s_add_u32 s38, s38, s63
  s_add_u32 s50, s38, 2048
  s_mov_b32 s54, s50
L_full5:
  s_add_u32 s80, s80, 16
  s_sub_u32 s81, s81, 1
  buffer_load_dwordx4 v[120:123], v1, s[48:51], s38 offen offset:0 nt
  buffer_load_dwordx4 v[124:127], v1, s[48:51], s38 offen offset:1024 nt
  buffer_load_dwordx4 v[128:131], v1, s[48:51], s38 offen offset:2048 nt
  buffer_load_dwordx4 v[132:135], v1, s[48:51], s38 offen offset:3072 nt
  s_cmp_le_u32 s81, 1
  s_cbranch_scc0 L_nr5
  s_add_u32 s90, s82, 1
  s_cmp_eq_u32 s83, 1
  s_addc_u32 s90, s90, 0
  s_mov_b64 exec, 1
  v_mov_b32 v21, s90
  ds_max_u32 v36, v21
  s_mov_b64 exec, -1
L_nr5:
  s_waitcnt vmcnt(8)
  buffer_load_dwordx4 a[80:83], v1, s[52:55], s38 offen offset:0 nt
  buffer_load_dwordx4 a[84:87], v1, s[52:55], s38 offen offset:1024 nt
  buffer_load_dwordx4 a[88:91], v1, s[52:55], s38 offen offset:2048 nt
  buffer_load_dwordx4 a[92:95], v1, s[52:55], s38 offen offset:3072 nt
L_nx5:
  s_branch L_sloop
L_sdone:
  v_add_f32_dpp v15, v15, v15 row_ror:4 row_mask:0xf bank_mask:0xf
  s_nop 1
  v_add_f32_dpp v15, v15, v15 row_ror:8 row_mask:0xf bank_mask:0xf
  v_mov_b32 v25, v15
  s_nop 1
  v_permlane16_swap_b32 v15, v25
  v_add_f32 v15, v15, v25
  v_mov_b32 v25, v15
  s_nop 1
  v_permlane32_swap_b32 v15, v25
  v_add_f32 v15, v15, v25
  v_lshrrev_b32 v16, 4, v0
  v_lshlrev_b32 v16, 7, v16
  v_and_b32 v17, 7, v0
  v_lshl_add_u32 v16, v17, 2, v16
  s_lshl_b32 s37, s3, 9
  v_add_u32 v16, s37, v16
  ds_write_b32 v16, v10 offset:1024
  ds_write_b32 v16, v11 offset:1056
  ds_write_b32 v16, v12 offset:1088
  ds_write_b32 v16, v13 offset:1120
  s_lshl_b32 s37, s3, 3
  v_mov_b32 v17, s37
  ds_write_b64 v17, v[14:15] offset:576
  s_waitcnt lgkmcnt(0)
  s_mov_b64 exec, 1
  v_mov_b32 v28, 516
  v_mov_b32 v29, 1
  ds_add_u32 v28, v29
  s_mov_b64 exec, -1
  s_endpgm
L_codeend:
  s_endpgm
.section .rodata,"a"
.p2align 6
.amdhsa_kernel recurrent_scan__mha_block_cached__dense_activation_squared_relu__decode_kernel
  .amdhsa_next_free_vgpr 232
  .amdhsa_next_free_sgpr 102
  .amdhsa_accum_offset 136
  .amdhsa_group_segment_fixed_size 0
  .amdhsa_kernarg_size 104
  .amdhsa_user_sgpr_count 2
  .amdhsa_user_sgpr_kernarg_segment_ptr 1
  .amdhsa_system_sgpr_workgroup_id_x 1
  .amdhsa_float_denorm_mode_32 3
.end_amdhsa_kernel
```
